```python
import torch

def _softmax(x, axis=-1):
    return torch.softmax(x, dim=axis)
def _gelu(x):
    return torch.nn.functional.gelu(x, approximate="tanh")
def _silu(x):
    return torch.nn.functional.silu(x)
def _sigmoid(x):
    return torch.sigmoid(x)
def _layernorm(x, axis=-1, eps=1e-5):
    m = x.mean(dim=axis, keepdim=True)
    v = x.var(dim=axis, keepdim=True, unbiased=False)
    return (x - m) / torch.sqrt(v + eps)
def _scatter_add(tgt, idx, src, axis=0):
    return tgt.clone().index_add_(axis, idx, src)
def _segment_sum(src, seg, n):
    out = torch.zeros((n,) + src.shape[1:], dtype=src.dtype)
    return out.index_add_(0, seg, src)
def _pad(x, pw):
    flat = tuple(v for pair in reversed(pw) for v in pair)
    return torch.nn.functional.pad(x, flat)

kernel_name = 'standalone__mixer_s_mlp__sampling'

def setup_inputs():

    _w = (lambda a: (lambda t: t.to(torch.bfloat16) if t.is_floating_point() else t)(torch.as_tensor(a)))
    B, S, D, F = 32, 32, 512, 1792
    return {
        "x":  _w((lambda *s: torch.randn(*s, dtype=torch.bfloat16) * 0.4)(B, S, D)),
        "w1": _w((lambda *s: torch.randn(*s, dtype=torch.bfloat16) * 3.2)(D, D) * (D ** -0.5)),
        "w2": _w((lambda *s: torch.randn(*s, dtype=torch.bfloat16) * 3.2)(D, D) * (D ** -0.5)),
        "w3": _w((lambda *s: torch.randn(*s, dtype=torch.bfloat16) * 3.2)(D, F) * (D ** -0.5)),
        "w4": _w((lambda *s: torch.randn(*s, dtype=torch.bfloat16) * 0.8)(F, D) * (F ** -0.5)),
    }

def reference(x, w1, w2, w3, w4):
    B, S, D = x.shape
    h = _gelu(_layernorm(x, axis=-1) @ w1)
    c = D // 4
    g0 = _pad(h[:, :, 0*c:1*c], ((0, 0), (1, 0), (0, 0)))[:, :S, :]
    g1 = _pad(h[:, :, 1*c:2*c], ((0, 0), (0, 1), (0, 0)))[:, 1:, :]
    g2 = _pad(h[:, :, 2*c:3*c], ((0, 0), (2, 0), (0, 0)))[:, :S, :]
    g3 = _pad(h[:, :, 3*c:   ], ((0, 0), (0, 2), (0, 0)))[:, 2:, :]
    hs = torch.concatenate([g0, g1, g2, g3], axis=-1) @ w2
    x1 = x + hs
    h2 = _gelu(_layernorm(x1, axis=-1) @ w3) @ w4
    return x1 + h2
```

```asm
; @launch grid=(256,1,1) block=(576,1,1) lds=163840
.amdgcn_target "amdgcn-amd-amdhsa--gfx950"
.text
.globl standalone__mixer_s_mlp__sampling_kernel
.p2align 8
.type standalone__mixer_s_mlp__sampling_kernel,@function
standalone__mixer_s_mlp__sampling_kernel:
    s_cmp_ge_u32 s2, 256
    s_cbranch_scc1 L_END
    s_load_dwordx16 s[4:19], s[0:1], 0
    v_lshrrev_b32 v28, 6, v0
    v_and_b32 v0, 63, v0
    v_readfirstlane_b32 s62, v28
    s_and_b32 s72, s2, 7
    s_lshr_b32 s73, s2, 3
    s_and_b32 s61, s73, 7
    s_lshr_b32 s73, s73, 3
    s_lshl_b32 s72, s72, 2
    s_add_u32 s60, s72, s73
    s_lshl_b32 s101, s73, 1
    s_and_b32 s100, s73, 1
    s_lshl_b32 s100, s100, 3
    s_add_u32 s100, s100, s61
    s_lshl_b32 s79, s61, 12
    s_lshl_b32 s71, s61, 7
    s_mov_b32 s63, 0
    s_cmp_eq_u32 s62, 8
    s_cbranch_scc1 L_CLASSL
    s_lshr_b32 s64, s62, 1
    s_lshl_b32 s73, s62, 2
    v_lshrrev_b32 v35, 4, v0
    v_add_u32 v35, s73, v35
    v_and_b32 v36, 15, v0
    v_lshlrev_b32 v38, 10, v35
    v_lshl_add_u32 v38, v36, 4, v38
    s_lshl_b32 s66, s62, 13
    s_add_u32 s66, s66, 32768
    s_add_u32 s67, s66, 65536
    s_waitcnt lgkmcnt(0)
    s_lshl_b32 s72, s60, 15
    s_add_u32 s20, s4, s72
    s_addc_u32 s21, s5, 0
    s_and_b32 s21, s21, 0xffff
    s_mov_b32 s22, 32768
    s_mov_b32 s23, 0x20000
    buffer_load_dwordx4 v[72:75], v38, s[20:23], 0 offen offset:0 nt
    buffer_load_dwordx4 v[76:79], v38, s[20:23], 0 offen offset:256 nt
    buffer_load_dwordx4 v[80:83], v38, s[20:23], 0 offen offset:512 nt
    buffer_load_dwordx4 v[84:87], v38, s[20:23], 0 offen offset:768 nt
    s_barrier
    s_cmp_ge_u32 s62, 4
    s_cbranch_scc0 L_NOPRIO
    s_setprio 1
L_NOPRIO:
    v_lshrrev_b32 v28, 2, v0
    v_and_b32 v29, 3, v0
    v_lshlrev_b32 v30, 4, v29
    v_lshrrev_b32 v31, 4, v0
    v_lshrrev_b32 v32, 5, v0
    v_and_b32 v34, 31, v0
    v_and_b32 v35, 1, v31
    s_and_b32 s73, s62, 1
    s_lshl_b32 s73, s73, 4
    v_and_b32 v36, 15, v0
    v_add_u32 v36, s73, v36
    s_lshl_b32 s74, s64, 5
    v_lshlrev_b32 v39, 10, v36
    v_lshl_add_u32 v39, v31, 3, v39
    v_add_u32 v39, s74, v39
    buffer_load_dwordx2 v[26:27], v39, s[20:23], s71 offen
    v_and_b32 v37, 3, v28
    v_lshlrev_b32 v144, 10, v37
    v_lshl_add_u32 v144, v35, 7, v144
    v_lshl_add_u32 v144, v32, 9, v144
    v_xor_b32 v37, s64, v37
    v_lshl_add_u32 v144, v37, 5, v144
    v_lshl_add_u32 v144, v29, 3, v144
    v_add_u32 v12, 32768, v144
    v_add_u32 v13, 98304, v144
    v_or_b32 v37, 0, v31
    v_xor_b32 v37, v37, v36
    v_lshlrev_b32 v37, 4, v37
    v_lshl_add_u32 v14, v31, 9, v37
    v_or_b32 v37, 12, v31
    v_xor_b32 v37, v37, v36
    v_lshlrev_b32 v37, 4, v37
    v_lshl_add_u32 v15, v31, 9, v37
    v_lshlrev_b32 v37, 4, v36
    v_lshl_add_u32 v16, v31, 9, v37
    s_lshl_b32 s74, s64, 10
    v_lshl_add_u32 v19, v32, 9, v37
    v_lshl_add_u32 v19, v35, 3, v19
    v_add_u32 v19, s74, v19
    s_lshl_b32 s73, s62, 2
    v_add_u32 v35, s73, v31
    v_and_b32 v36, 15, v0
    v_bfe_u32 v37, v0, 2, 1
    v_mul_u32_u24 v37, 12, v37
    v_or_b32 v37, v37, v29
    v_xor_b32 v37, v37, v35
    v_lshlrev_b32 v37, 4, v37
    v_lshl_add_u32 v17, v36, 9, v37
    s_waitcnt vmcnt(1)
    s_mov_b32 s72, 0x3f803f80
    v_dot2_f32_bf16 v28, v72, s72, 0
    v_dot2_f32_bf16 v32, v72, v72, 0
    v_dot2_f32_bf16 v29, v73, s72, 0
    v_dot2_f32_bf16 v33, v73, v73, 0
    v_dot2_f32_bf16 v30, v74, s72, 0
    v_dot2_f32_bf16 v34, v74, v74, 0
    v_dot2_f32_bf16 v31, v75, s72, 0
    v_dot2_f32_bf16 v35, v75, v75, 0
    v_dot2_f32_bf16 v28, v76, s72, v28
    v_dot2_f32_bf16 v32, v76, v76, v32
    v_dot2_f32_bf16 v29, v77, s72, v29
    v_dot2_f32_bf16 v33, v77, v77, v33
    v_dot2_f32_bf16 v30, v78, s72, v30
    v_dot2_f32_bf16 v34, v78, v78, v34
    v_dot2_f32_bf16 v31, v79, s72, v31
    v_dot2_f32_bf16 v35, v79, v79, v35
    v_dot2_f32_bf16 v28, v80, s72, v28
    v_dot2_f32_bf16 v32, v80, v80, v32
    v_dot2_f32_bf16 v29, v81, s72, v29
    v_dot2_f32_bf16 v33, v81, v81, v33
    v_dot2_f32_bf16 v30, v82, s72, v30
    v_dot2_f32_bf16 v34, v82, v82, v34
    v_dot2_f32_bf16 v31, v83, s72, v31
    v_dot2_f32_bf16 v35, v83, v83, v35
    v_dot2_f32_bf16 v28, v84, s72, v28
    v_dot2_f32_bf16 v32, v84, v84, v32
    v_dot2_f32_bf16 v29, v85, s72, v29
    v_dot2_f32_bf16 v33, v85, v85, v33
    v_dot2_f32_bf16 v30, v86, s72, v30
    v_dot2_f32_bf16 v34, v86, v86, v34
    v_dot2_f32_bf16 v31, v87, s72, v31
    v_dot2_f32_bf16 v35, v87, v87, v35
    v_lshlrev_b32 v40, 16, v72
    v_and_b32 v41, 0xffff0000, v72
    v_lshlrev_b32 v42, 16, v73
    v_add_f32 v28, v28, v29
    v_add_f32 v30, v30, v31
    v_add_f32 v32, v32, v33
    v_add_f32 v34, v34, v35
    v_and_b32 v43, 0xffff0000, v73
    v_add_f32 v28, v28, v30
    v_add_f32 v32, v32, v34
    v_lshlrev_b32 v44, 16, v74
    v_and_b32 v45, 0xffff0000, v74
    v_add_f32_dpp v28, v28, v28 row_ror:8 row_mask:0xf bank_mask:0xf
    v_add_f32_dpp v32, v32, v32 row_ror:8 row_mask:0xf bank_mask:0xf
    v_lshlrev_b32 v46, 16, v75
    v_and_b32 v47, 0xffff0000, v75
    v_add_f32_dpp v28, v28, v28 row_ror:4 row_mask:0xf bank_mask:0xf
    v_add_f32_dpp v32, v32, v32 row_ror:4 row_mask:0xf bank_mask:0xf
    v_lshlrev_b32 v48, 16, v76
    v_and_b32 v49, 0xffff0000, v76
    v_add_f32_dpp v28, v28, v28 row_ror:2 row_mask:0xf bank_mask:0xf
    v_add_f32_dpp v32, v32, v32 row_ror:2 row_mask:0xf bank_mask:0xf
    v_lshlrev_b32 v50, 16, v77
    v_and_b32 v51, 0xffff0000, v77
    v_add_f32_dpp v28, v28, v28 row_ror:1 row_mask:0xf bank_mask:0xf
    v_add_f32_dpp v32, v32, v32 row_ror:1 row_mask:0xf bank_mask:0xf
    v_lshlrev_b32 v52, 16, v78
    v_and_b32 v53, 0xffff0000, v78
    v_mul_f32 v28, 0x3b000000, v28
    v_mov_b32 v36, 0x3727c5ac
    v_lshlrev_b32 v54, 16, v79
    v_and_b32 v55, 0xffff0000, v79
    v_fmac_f32 v36, 0x3b000000, v32
    v_lshlrev_b32 v56, 16, v80
    v_fma_f32 v36, -v28, v28, v36
    v_and_b32 v57, 0xffff0000, v80
    v_max_f32 v36, 0x3727c5ac, v36
    v_lshlrev_b32 v58, 16, v81
    v_rsq_f32 v36, v36
    v_and_b32 v59, 0xffff0000, v81
    v_lshlrev_b32 v60, 16, v82
    v_and_b32 v61, 0xffff0000, v82
    v_lshlrev_b32 v62, 16, v83
    v_and_b32 v63, 0xffff0000, v83
    v_lshlrev_b32 v64, 16, v84
    v_and_b32 v65, 0xffff0000, v84
    v_lshlrev_b32 v66, 16, v85
    v_and_b32 v67, 0xffff0000, v85
    v_lshlrev_b32 v68, 16, v86
    v_and_b32 v69, 0xffff0000, v86
    v_lshlrev_b32 v70, 16, v87
    v_and_b32 v71, 0xffff0000, v87
    v_mul_f32 v37, v28, v36
    v_fma_f32 v40, v40, v36, -v37
    v_fma_f32 v41, v41, v36, -v37
    v_fma_f32 v42, v42, v36, -v37
    v_fma_f32 v43, v43, v36, -v37
    v_fma_f32 v44, v44, v36, -v37
    v_fma_f32 v45, v45, v36, -v37
    v_fma_f32 v46, v46, v36, -v37
    v_fma_f32 v47, v47, v36, -v37
    v_cvt_pk_bf16_f32 v72, v40, v41
    v_cvt_pk_bf16_f32 v73, v42, v43
    v_cvt_pk_bf16_f32 v74, v44, v45
    v_cvt_pk_bf16_f32 v75, v46, v47
    ds_write_b128 v17, v[72:75] offset:0
    v_fma_f32 v48, v48, v36, -v37
    v_fma_f32 v49, v49, v36, -v37
    v_fma_f32 v50, v50, v36, -v37
    v_fma_f32 v51, v51, v36, -v37
    v_fma_f32 v52, v52, v36, -v37
    v_fma_f32 v53, v53, v36, -v37
    v_fma_f32 v54, v54, v36, -v37
    v_fma_f32 v55, v55, v36, -v37
    v_cvt_pk_bf16_f32 v76, v48, v49
    v_cvt_pk_bf16_f32 v77, v50, v51
    v_cvt_pk_bf16_f32 v78, v52, v53
    v_cvt_pk_bf16_f32 v79, v54, v55
    ds_write_b128 v17, v[76:79] offset:8192
    v_fma_f32 v56, v56, v36, -v37
    v_fma_f32 v57, v57, v36, -v37
    v_fma_f32 v58, v58, v36, -v37
    v_fma_f32 v59, v59, v36, -v37
    v_fma_f32 v60, v60, v36, -v37
    v_fma_f32 v61, v61, v36, -v37
    v_fma_f32 v62, v62, v36, -v37
    v_fma_f32 v63, v63, v36, -v37
    v_cvt_pk_bf16_f32 v80, v56, v57
    v_cvt_pk_bf16_f32 v81, v58, v59
    v_cvt_pk_bf16_f32 v82, v60, v61
    v_cvt_pk_bf16_f32 v83, v62, v63
    ds_write_b128 v17, v[80:83] offset:16384
    v_fma_f32 v64, v64, v36, -v37
    v_fma_f32 v65, v65, v36, -v37
    v_fma_f32 v66, v66, v36, -v37
    v_fma_f32 v67, v67, v36, -v37
    v_fma_f32 v68, v68, v36, -v37
    v_fma_f32 v69, v69, v36, -v37
    v_fma_f32 v70, v70, v36, -v37
    v_fma_f32 v71, v71, v36, -v37
    v_cvt_pk_bf16_f32 v84, v64, v65
    v_cvt_pk_bf16_f32 v85, v66, v67
    v_cvt_pk_bf16_f32 v86, v68, v69
    v_cvt_pk_bf16_f32 v87, v70, v71
    ds_write_b128 v17, v[84:87] offset:24576
    s_waitcnt lgkmcnt(0)
    s_barrier
    ds_read_b128 v[40:43], v14 offset:0
    ds_read_b128 v[44:47], v15 offset:2048
    ds_read_b128 v[48:51], v14 offset:4096
    ds_read_b128 v[52:55], v15 offset:6144
    ds_read_b128 v[56:59], v14 offset:8192
    ds_read_b128 v[60:63], v15 offset:10240
    ds_read_b128 v[64:67], v14 offset:12288
    ds_read_b128 v[68:71], v15 offset:14336
    ds_read_b128 v[72:75], v14 offset:16384
    ds_read_b128 v[76:79], v15 offset:18432
    ds_read_b128 v[80:83], v14 offset:20480
    ds_read_b128 v[84:87], v15 offset:22528
    ds_read_b128 v[88:91], v14 offset:24576
    ds_read_b128 v[92:95], v15 offset:26624
    ds_read_b128 v[96:99], v14 offset:28672
    ds_read_b128 v[100:103], v15 offset:30720
    s_lshl_b32 s72, s60, 15
    s_add_u32 s44, s18, s72
    s_addc_u32 s45, s19, 0
    s_and_b32 s45, s45, 0xffff
    s_mov_b32 s46, 32768
    s_mov_b32 s47, 0x20000
    s_add_u32 s73, s72, 1048576
    s_add_u32 s48, s18, s73
    s_addc_u32 s49, s19, 0
    s_and_b32 s49, s49, 0xffff
    s_mov_b32 s50, 32768
    s_mov_b32 s51, 0x20000
    s_waitcnt lgkmcnt(0)
    s_barrier
    ds_read_b64_tr_b16 v[104:105], v12 offset:0
    ds_read_b64_tr_b16 v[106:107], v12 offset:256
    ds_read_b64_tr_b16 v[108:109], v12 offset:4096
    ds_read_b64_tr_b16 v[110:111], v12 offset:4352
    ds_read_b64_tr_b16 v[112:113], v12 offset:8192
    ds_read_b64_tr_b16 v[114:115], v12 offset:8448
    ds_read_b64_tr_b16 v[116:117], v12 offset:12288
    ds_read_b64_tr_b16 v[118:119], v12 offset:12544
    ds_read_b64_tr_b16 v[120:121], v12 offset:16384
    ds_read_b64_tr_b16 v[122:123], v12 offset:16640
    ds_read_b64_tr_b16 v[124:125], v12 offset:20480
    ds_read_b64_tr_b16 v[126:127], v12 offset:20736
    ds_read_b64_tr_b16 v[128:129], v12 offset:24576
    ds_read_b64_tr_b16 v[130:131], v12 offset:24832
    s_waitcnt lgkmcnt(12)
    v_mfma_f32_16x16x32_bf16 v[136:139], v[104:107], v[40:43], 0
    ds_read_b64_tr_b16 v[132:133], v12 offset:28672
    ds_read_b64_tr_b16 v[134:135], v12 offset:28928
    s_waitcnt lgkmcnt(12)
    v_mfma_f32_16x16x32_bf16 v[140:143], v[108:111], v[44:47], 0
    ds_read_b64_tr_b16 v[104:105], v12 offset:32768
    ds_read_b64_tr_b16 v[106:107], v12 offset:33024
    s_waitcnt lgkmcnt(12)
    v_mfma_f32_16x16x32_bf16 v[136:139], v[112:115], v[48:51], v[136:139]
    ds_read_b64_tr_b16 v[108:109], v12 offset:36864
    ds_read_b64_tr_b16 v[110:111], v12 offset:37120
    s_waitcnt lgkmcnt(12)
    v_mfma_f32_16x16x32_bf16 v[140:143], v[116:119], v[52:55], v[140:143]
    ds_read_b64_tr_b16 v[112:113], v12 offset:40960
    ds_read_b64_tr_b16 v[114:115], v12 offset:41216
    s_waitcnt lgkmcnt(12)
    v_mfma_f32_16x16x32_bf16 v[136:139], v[120:123], v[56:59], v[136:139]
    ds_read_b64_tr_b16 v[116:117], v12 offset:45056
    ds_read_b64_tr_b16 v[118:119], v12 offset:45312
    s_waitcnt lgkmcnt(12)
    v_mfma_f32_16x16x32_bf16 v[140:143], v[124:127], v[60:63], v[140:143]
    ds_read_b64_tr_b16 v[120:121], v12 offset:49152
    ds_read_b64_tr_b16 v[122:123], v12 offset:49408
    s_waitcnt lgkmcnt(12)
    v_mfma_f32_16x16x32_bf16 v[136:139], v[128:131], v[64:67], v[136:139]
    ds_read_b64_tr_b16 v[124:125], v12 offset:53248
    ds_read_b64_tr_b16 v[126:127], v12 offset:53504
    s_waitcnt lgkmcnt(12)
    v_mfma_f32_16x16x32_bf16 v[140:143], v[132:135], v[68:71], v[140:143]
    ds_read_b64_tr_b16 v[128:129], v12 offset:57344
    ds_read_b64_tr_b16 v[130:131], v12 offset:57600
    s_waitcnt lgkmcnt(12)
    v_mfma_f32_16x16x32_bf16 v[136:139], v[104:107], v[72:75], v[136:139]
    ds_read_b64_tr_b16 v[132:133], v12 offset:61440
    ds_read_b64_tr_b16 v[134:135], v12 offset:61696
    s_waitcnt lgkmcnt(12)
    v_mfma_f32_16x16x32_bf16 v[140:143], v[108:111], v[76:79], v[140:143]
    s_waitcnt lgkmcnt(10)
    v_mfma_f32_16x16x32_bf16 v[136:139], v[112:115], v[80:83], v[136:139]
    s_waitcnt lgkmcnt(8)
    v_mfma_f32_16x16x32_bf16 v[140:143], v[116:119], v[84:87], v[140:143]
    s_waitcnt lgkmcnt(6)
    v_mfma_f32_16x16x32_bf16 v[136:139], v[120:123], v[88:91], v[136:139]
    s_waitcnt lgkmcnt(4)
    v_mfma_f32_16x16x32_bf16 v[140:143], v[124:127], v[92:95], v[140:143]
    s_waitcnt lgkmcnt(2)
    v_mfma_f32_16x16x32_bf16 v[136:139], v[128:131], v[96:99], v[136:139]
    s_waitcnt lgkmcnt(0)
    v_mfma_f32_16x16x32_bf16 v[140:143], v[132:135], v[100:103], v[140:143]
    s_barrier
    v_mov_b32 v35, 0
    ds_read_b32 v34, v35
    s_nop 4
    v_add_f32 v136, v136, v140
    v_add_f32 v137, v137, v141
    v_add_f32 v138, v138, v142
    v_add_f32 v139, v139, v143
    s_mov_b32 s72, 0xbdd2d3e8
    s_mov_b32 s73, 0xbdd2d3e8
    v_mov_b32 v36, 0xc0135761
    v_mov_b32 v37, 0xc0135761
    v_pk_mul_f32 v[144:145], v[136:137], v[136:137]
    v_pk_mul_f32 v[146:147], v[138:139], v[138:139]
    v_pk_fma_f32 v[144:145], v[144:145], s[72:73], v[36:37]
    v_pk_fma_f32 v[146:147], v[146:147], s[72:73], v[36:37]
    v_pk_mul_f32 v[144:145], v[144:145], v[136:137]
    v_pk_mul_f32 v[146:147], v[146:147], v[138:139]
    v_exp_f32 v144, v144
    v_exp_f32 v145, v145
    v_exp_f32 v146, v146
    v_exp_f32 v147, v147
    v_pk_add_f32 v[144:145], v[144:145], 1.0 op_sel_hi:[1,0]
    v_pk_add_f32 v[146:147], v[146:147], 1.0 op_sel_hi:[1,0]
    v_rcp_f32 v144, v144
    v_rcp_f32 v145, v145
    v_rcp_f32 v146, v146
    v_rcp_f32 v147, v147
    v_pk_mul_f32 v[136:137], v[136:137], v[144:145]
    v_pk_mul_f32 v[138:139], v[138:139], v[146:147]
    s_waitcnt lgkmcnt(0)
    v_readfirstlane_b32 s63, v34
    v_cvt_pk_bf16_f32 v136, v136, v137
    v_cvt_pk_bf16_f32 v137, v138, v139
    s_cmp_eq_u32 s63, 0
    s_cbranch_scc1 L_SLOW1
    buffer_store_dwordx2 v[136:137], v19, s[44:47], s79 offen
    s_branch L_DONE1
L_SLOW1:
    buffer_store_dwordx2 v[136:137], v19, s[44:47], s79 offen sc1
L_DONE1:
    s_waitcnt vmcnt(0)
    s_barrier
    ds_read_b64_tr_b16 v[40:41], v13 offset:0
    ds_read_b64_tr_b16 v[42:43], v13 offset:256
    ds_read_b64_tr_b16 v[44:45], v13 offset:4096
    ds_read_b64_tr_b16 v[46:47], v13 offset:4352
    ds_read_b64_tr_b16 v[48:49], v13 offset:8192
    ds_read_b64_tr_b16 v[50:51], v13 offset:8448
    ds_read_b64_tr_b16 v[52:53], v13 offset:12288
    ds_read_b64_tr_b16 v[54:55], v13 offset:12544
    ds_read_b64_tr_b16 v[56:57], v13 offset:16384
    ds_read_b64_tr_b16 v[58:59], v13 offset:16640
    ds_read_b64_tr_b16 v[60:61], v13 offset:20480
    ds_read_b64_tr_b16 v[62:63], v13 offset:20736
    ds_read_b64_tr_b16 v[64:65], v13 offset:24576
    ds_read_b64_tr_b16 v[66:67], v13 offset:24832
    ds_read_b64_tr_b16 v[68:69], v13 offset:28672
    ds_read_b64_tr_b16 v[70:71], v13 offset:28928
    ds_read_b64_tr_b16 v[72:73], v13 offset:32768
    ds_read_b64_tr_b16 v[74:75], v13 offset:33024
    ds_read_b64_tr_b16 v[76:77], v13 offset:36864
    ds_read_b64_tr_b16 v[78:79], v13 offset:37120
    ds_read_b64_tr_b16 v[80:81], v13 offset:40960
    ds_read_b64_tr_b16 v[82:83], v13 offset:41216
    ds_read_b64_tr_b16 v[84:85], v13 offset:45056
    ds_read_b64_tr_b16 v[86:87], v13 offset:45312
    ds_read_b64_tr_b16 v[88:89], v13 offset:49152
    ds_read_b64_tr_b16 v[90:91], v13 offset:49408
    ds_read_b64_tr_b16 v[92:93], v13 offset:53248
    ds_read_b64_tr_b16 v[94:95], v13 offset:53504
    ds_read_b64_tr_b16 v[96:97], v13 offset:57344
    ds_read_b64_tr_b16 v[98:99], v13 offset:57600
    ds_read_b64_tr_b16 v[100:101], v13 offset:61440
    ds_read_b64_tr_b16 v[102:103], v13 offset:61696
    s_lshl_b32 s72, s60, 15
    s_add_u32 s40, s14, s72
    s_addc_u32 s41, s15, 0
    s_and_b32 s41, s41, 0xffff
    s_mov_b32 s42, 32768
    s_mov_b32 s43, 0x20000
    s_mov_b32 s32, s10
    s_and_b32 s33, s11, 0xffff
    s_mov_b32 s34, 1835008
    s_mov_b32 s35, 0x20000
    s_mov_b32 s36, s12
    s_and_b32 s37, s13, 0xffff
    s_mov_b32 s38, 1835008
    s_mov_b32 s39, 0x20000
    s_and_b32 s74, s60, 0xfffffffe
    s_lshl_b32 s73, s74, 15
    s_add_u32 s73, s73, 1048576
    s_add_u32 s20, s18, s73
    s_addc_u32 s21, s19, 0
    s_and_b32 s21, s21, 0xffff
    s_mov_b32 s22, 65536
    s_mov_b32 s23, 0x20000
    s_lshl_b32 s73, s74, 17
    s_add_u32 s73, s73, 2097152
    s_add_u32 s52, s18, s73
    s_addc_u32 s53, s19, 0
    s_and_b32 s53, s53, 0xffff
    s_mov_b32 s54, 262144
    s_mov_b32 s55, 0x20000
    s_mul_i32 s66, s62, 12288
    s_add_u32 s66, s66, 65536
    s_mov_b32 s24, 0
    s_mov_b32 s25, 8192
    s_mov_b32 s26, 16384
    s_mov_b32 s27, 24576
    s_mov_b32 s28, 32768
    s_mov_b32 s29, 40960
    s_mov_b32 s30, 49152
    s_mov_b32 s31, 57344
    s_lshl_b32 s69, s100, 8
    s_and_b32 s73, s62, 3
    s_lshl_b32 s75, s73, 6
    s_add_u32 s69, s69, s75
    s_lshr_b32 s56, s62, 2
    s_mul_i32 s75, s56, 917504
    s_add_u32 s69, s69, s75
    s_mul_i32 s70, s62, 229376
    s_add_u32 s70, s70, s71
    s_lshl_b32 s57, s56, 17
    s_lshl_b32 s75, s100, 13
    s_add_u32 s57, s57, s75
    s_and_b32 s58, s60, 1
    s_lshl_b32 s58, s58, 17
    s_mul_i32 s75, s62, 14336
    s_add_u32 s58, s58, s75
    v_lshrrev_b32 v28, 2, v0
    v_and_b32 v29, 3, v0
    v_lshlrev_b32 v30, 4, v29
    v_lshrrev_b32 v31, 4, v0
    v_lshrrev_b32 v32, 5, v0
    v_and_b32 v34, 31, v0
    v_and_b32 v35, 1, v31
    s_and_b32 s73, s62, 1
    s_lshl_b32 s73, s73, 4
    v_and_b32 v36, 15, v0
    v_add_u32 v36, s73, v36
    s_movk_i32 s72, 3584
    v_mad_u32_u24 v1, v28, s72, v30
    v_and_b32 v33, 7, v28
    v_lshl_add_u32 v2, v33, 10, v30
    v_lshl_add_u32 v2, v32, 6, v2
    v_and_b32 v33, 3, v28
    v_lshlrev_b32 v33, 6, v33
    v_lshl_add_u32 v33, v29, 3, v33
    v_lshl_add_u32 v33, v35, 5, v33
    v_lshl_add_u32 v36, v32, 9, v33
    v_add_u32 v3, s66, v36
    v_lshl_add_u32 v36, v32, 10, v33
    v_add_u32 v5, s66, v36
    s_lshl_b32 s59, s62, 13
    v_add_u32 v39, s59, v36
    v_lshlrev_b32 v11, 4, v0
    v_lshlrev_b32 v36, 2, v32
    v_xor_b32 v36, v34, v36
    s_lshl_b32 s75, s56, 14
    v_xor_b32 v37, 0, v36
    v_lshlrev_b32 v37, 4, v37
    v_lshl_add_u32 v7, v32, 9, v37
    v_add_u32 v7, s75, v7
    v_xor_b32 v37, 1, v36
    v_lshlrev_b32 v37, 4, v37
    v_lshl_add_u32 v8, v32, 9, v37
    v_add_u32 v8, s75, v8
    v_xor_b32 v37, 2, v36
    v_lshlrev_b32 v37, 4, v37
    v_lshl_add_u32 v9, v32, 9, v37
    v_add_u32 v9, s75, v9
    v_xor_b32 v37, 3, v36
    v_lshlrev_b32 v37, 4, v37
    v_lshl_add_u32 v10, v32, 9, v37
    v_add_u32 v10, s75, v10
    s_lshl_b32 s73, s62, 2
    v_add_u32 v35, s73, v29
    v_lshlrev_b32 v20, 4, v35
    v_lshl_add_u32 v20, v28, 9, v20
    v_and_b32 v36, 1, v28
    v_lshlrev_b32 v36, 2, v36
    v_bfe_u32 v37, v28, 1, 2
    v_or_b32 v36, v36, v37
    v_xor_b32 v36, v36, v35
    v_lshlrev_b32 v36, 4, v36
    v_lshl_add_u32 v18, v28, 9, v36
    s_lshl_b32 s73, s62, 9
    v_lshlrev_b32 v21, 4, v34
    v_lshl_add_u32 v21, v32, 3, v21
    v_add_u32 v21, s73, v21
    s_lshl_b32 s73, s62, 4
    v_lshlrev_b32 v22, 10, v34
    v_lshl_add_u32 v22, v32, 3, v22
    v_add_u32 v22, s73, v22
    s_and_b32 s73, s62, 3
    s_lshl_b32 s73, s73, 11
    v_add_u32 v23, s73, v11
    v_add_u32 v24, s66, v11
    s_lshl_b32 s73, s62, 10
    s_add_u32 s73, s73, 65536
    v_add_u32 v25, s73, v11
    v_add_u32 v4, 49152, v25
    s_xor_b32 s73, s62, 4
    s_mul_i32 s73, s73, 12288
    s_add_u32 s73, s73, 65536
    v_add_u32 v6, s73, v11
    s_waitcnt lgkmcnt(0)
    s_barrier
    ds_read_b128 v[104:107], v16 offset:0
    ds_read_b128 v[108:111], v16 offset:2048
    ds_read_b128 v[112:115], v16 offset:4096
    ds_read_b128 v[116:119], v16 offset:6144
    ds_read_b128 v[120:123], v16 offset:8192
    ds_read_b128 v[124:127], v16 offset:10240
    ds_read_b128 v[128:131], v16 offset:12288
    ds_read_b128 v[132:135], v16 offset:14336
    s_cmp_eq_u32 s63, 1
    s_cbranch_scc1 L_MODEOKA
    v_mov_b32 v35, 32832
    ds_read_b32 v34, v35
    s_waitcnt lgkmcnt(0)
    v_readfirstlane_b32 s63, v34
L_MODEOKA:
    s_waitcnt lgkmcnt(7)
    v_mfma_f32_16x16x32_bf16 v[136:139], v[40:43], v[104:107], 0
    ds_read_b128 v[104:107], v16 offset:16384
    s_waitcnt lgkmcnt(7)
    v_mfma_f32_16x16x32_bf16 v[140:143], v[44:47], v[108:111], 0
    ds_read_b128 v[108:111], v16 offset:18432
    s_waitcnt lgkmcnt(7)
    v_mfma_f32_16x16x32_bf16 v[136:139], v[48:51], v[112:115], v[136:139]
    ds_read_b128 v[112:115], v16 offset:20480
    s_waitcnt lgkmcnt(7)
    v_mfma_f32_16x16x32_bf16 v[140:143], v[52:55], v[116:119], v[140:143]
    ds_read_b128 v[116:119], v16 offset:22528
    s_waitcnt lgkmcnt(7)
    v_mfma_f32_16x16x32_bf16 v[136:139], v[56:59], v[120:123], v[136:139]
    ds_read_b128 v[120:123], v16 offset:24576
    s_waitcnt lgkmcnt(7)
    v_mfma_f32_16x16x32_bf16 v[140:143], v[60:63], v[124:127], v[140:143]
    ds_read_b128 v[124:127], v16 offset:26624
    s_waitcnt lgkmcnt(7)
    v_mfma_f32_16x16x32_bf16 v[136:139], v[64:67], v[128:131], v[136:139]
    ds_read_b128 v[128:131], v16 offset:28672
    s_waitcnt lgkmcnt(7)
    v_mfma_f32_16x16x32_bf16 v[140:143], v[68:71], v[132:135], v[140:143]
    ds_read_b128 v[132:135], v16 offset:30720
    s_waitcnt lgkmcnt(7)
    v_mfma_f32_16x16x32_bf16 v[136:139], v[72:75], v[104:107], v[136:139]
    s_waitcnt lgkmcnt(6)
    v_mfma_f32_16x16x32_bf16 v[140:143], v[76:79], v[108:111], v[140:143]
    s_waitcnt lgkmcnt(5)
    v_mfma_f32_16x16x32_bf16 v[136:139], v[80:83], v[112:115], v[136:139]
    s_waitcnt lgkmcnt(4)
    v_mfma_f32_16x16x32_bf16 v[140:143], v[84:87], v[116:119], v[140:143]
    s_waitcnt lgkmcnt(3)
    v_mfma_f32_16x16x32_bf16 v[136:139], v[88:91], v[120:123], v[136:139]
    s_waitcnt lgkmcnt(2)
    v_mfma_f32_16x16x32_bf16 v[140:143], v[92:95], v[124:127], v[140:143]
    s_waitcnt lgkmcnt(1)
    v_mfma_f32_16x16x32_bf16 v[136:139], v[96:99], v[128:131], v[136:139]
    s_waitcnt lgkmcnt(0)
    v_mfma_f32_16x16x32_bf16 v[140:143], v[100:103], v[132:135], v[140:143]
    v_lshlrev_b32 v28, 16, v26
    v_and_b32 v29, 0xffff0000, v26
    v_lshlrev_b32 v30, 16, v27
    v_and_b32 v31, 0xffff0000, v27
    s_nop 3
    v_add_f32 v28, v28, v140
    v_add_f32 v29, v29, v141
    v_add_f32 v30, v30, v142
    v_add_f32 v31, v31, v143
    v_add_f32 v136, v136, v28
    v_add_f32 v137, v137, v29
    v_add_f32 v138, v138, v30
    v_add_f32 v139, v139, v31
    v_cvt_pk_bf16_f32 v136, v136, v137
    v_cvt_pk_bf16_f32 v137, v138, v139
    s_cmp_eq_u32 s63, 0
    s_cbranch_scc1 L_SLOW2
    buffer_store_dwordx2 v[136:137], v19, s[48:51], s79 offen
    s_branch L_DONE2
L_SLOW2:
    buffer_store_dwordx2 v[136:137], v19, s[48:51], s79 offen sc1
L_DONE2:
    s_waitcnt vmcnt(0)
    s_barrier
    s_barrier
    s_cmp_eq_u32 s63, 1
    s_cbranch_scc1 L_MODEOK3
    v_mov_b32 v35, 32896
    ds_read_b32 v34, v35
    s_waitcnt lgkmcnt(0)
    v_readfirstlane_b32 s63, v34
L_MODEOK3:
    s_nop 1
    s_cmp_eq_u32 s63, 0
    s_cbranch_scc1 L_SLOW3
    buffer_load_dwordx2 v[26:27], v21, s[48:51], s79 offen nt
    s_branch L_DONE3
L_SLOW3:
    buffer_load_dwordx2 v[26:27], v21, s[48:51], s79 offen sc1
L_DONE3:
    s_cmp_ge_u32 s100, 14
    s_cbranch_scc1 L_IDLECU
    s_cmp_eq_u32 s63, 0
    s_cbranch_scc1 L_SLOW4
    buffer_load_dwordx4 v[72:75], v20, s[20:23], s24 offen nt
    buffer_load_dwordx4 v[76:79], v20, s[20:23], s25 offen nt
    buffer_load_dwordx4 v[80:83], v20, s[20:23], s26 offen nt
    buffer_load_dwordx4 v[84:87], v20, s[20:23], s27 offen nt
    buffer_load_dwordx4 v[104:107], v20, s[20:23], s28 offen nt
    buffer_load_dwordx4 v[108:111], v20, s[20:23], s29 offen nt
    buffer_load_dwordx4 v[112:115], v20, s[20:23], s30 offen nt
    buffer_load_dwordx4 v[116:119], v20, s[20:23], s31 offen nt
    s_branch L_DONE4
L_SLOW4:
    buffer_load_dwordx4 v[72:75], v20, s[20:23], s24 offen sc1
    buffer_load_dwordx4 v[76:79], v20, s[20:23], s25 offen sc1
    buffer_load_dwordx4 v[80:83], v20, s[20:23], s26 offen sc1
    buffer_load_dwordx4 v[84:87], v20, s[20:23], s27 offen sc1
    buffer_load_dwordx4 v[104:107], v20, s[20:23], s28 offen sc1
    buffer_load_dwordx4 v[108:111], v20, s[20:23], s29 offen sc1
    buffer_load_dwordx4 v[112:115], v20, s[20:23], s30 offen sc1
    buffer_load_dwordx4 v[116:119], v20, s[20:23], s31 offen sc1
L_DONE4:
    s_barrier
    s_waitcnt vmcnt(4)
    s_mov_b32 s72, 0x3f803f80
    v_dot2_f32_bf16 v28, v72, s72, 0
    v_dot2_f32_bf16 v32, v72, v72, 0
    v_dot2_f32_bf16 v29, v73, s72, 0
    v_dot2_f32_bf16 v33, v73, v73, 0
    v_dot2_f32_bf16 v30, v74, s72, 0
    v_dot2_f32_bf16 v34, v74, v74, 0
    v_dot2_f32_bf16 v31, v75, s72, 0
    v_dot2_f32_bf16 v35, v75, v75, 0
    v_dot2_f32_bf16 v28, v76, s72, v28
    v_dot2_f32_bf16 v32, v76, v76, v32
    v_dot2_f32_bf16 v29, v77, s72, v29
    v_dot2_f32_bf16 v33, v77, v77, v33
    v_dot2_f32_bf16 v30, v78, s72, v30
    v_dot2_f32_bf16 v34, v78, v78, v34
    v_dot2_f32_bf16 v31, v79, s72, v31
    v_dot2_f32_bf16 v35, v79, v79, v35
    v_dot2_f32_bf16 v28, v80, s72, v28
    v_dot2_f32_bf16 v32, v80, v80, v32
    v_dot2_f32_bf16 v29, v81, s72, v29
    v_dot2_f32_bf16 v33, v81, v81, v33
    v_dot2_f32_bf16 v30, v82, s72, v30
    v_dot2_f32_bf16 v34, v82, v82, v34
    v_dot2_f32_bf16 v31, v83, s72, v31
    v_dot2_f32_bf16 v35, v83, v83, v35
    v_dot2_f32_bf16 v28, v84, s72, v28
    v_dot2_f32_bf16 v32, v84, v84, v32
    v_dot2_f32_bf16 v29, v85, s72, v29
    v_dot2_f32_bf16 v33, v85, v85, v33
    v_dot2_f32_bf16 v30, v86, s72, v30
    v_dot2_f32_bf16 v34, v86, v86, v34
    v_dot2_f32_bf16 v31, v87, s72, v31
    v_dot2_f32_bf16 v35, v87, v87, v35
    v_lshlrev_b32 v40, 16, v72
    v_and_b32 v41, 0xffff0000, v72
    v_lshlrev_b32 v42, 16, v73
    v_add_f32 v28, v28, v29
    v_add_f32 v30, v30, v31
    v_add_f32 v32, v32, v33
    v_add_f32 v34, v34, v35
    v_and_b32 v43, 0xffff0000, v73
    v_add_f32 v28, v28, v30
    v_add_f32 v32, v32, v34
    v_lshlrev_b32 v44, 16, v74
    v_and_b32 v45, 0xffff0000, v74
    v_add_f32_dpp v28, v28, v28 row_ror:8 row_mask:0xf bank_mask:0xf
    v_add_f32_dpp v32, v32, v32 row_ror:8 row_mask:0xf bank_mask:0xf
    v_lshlrev_b32 v46, 16, v75
    v_and_b32 v47, 0xffff0000, v75
    v_add_f32_dpp v28, v28, v28 row_ror:4 row_mask:0xf bank_mask:0xf
    v_add_f32_dpp v32, v32, v32 row_ror:4 row_mask:0xf bank_mask:0xf
    v_lshlrev_b32 v48, 16, v76
    v_and_b32 v49, 0xffff0000, v76
    v_mov_b32 v36, v28
    v_mov_b32 v37, v32
    v_lshlrev_b32 v50, 16, v77
    v_and_b32 v51, 0xffff0000, v77
    v_permlane16_swap_b32 v28, v36
    v_permlane16_swap_b32 v32, v37
    v_lshlrev_b32 v52, 16, v78
    v_add_f32 v28, v28, v36
    v_add_f32 v32, v32, v37
    v_and_b32 v53, 0xffff0000, v78
    v_lshlrev_b32 v54, 16, v79
    v_mov_b32 v36, v28
    v_mov_b32 v37, v32
    v_and_b32 v55, 0xffff0000, v79
    v_lshlrev_b32 v56, 16, v80
    v_permlane32_swap_b32 v28, v36
    v_permlane32_swap_b32 v32, v37
    v_and_b32 v57, 0xffff0000, v80
    v_add_f32 v28, v28, v36
    v_add_f32 v32, v32, v37
    v_lshlrev_b32 v58, 16, v81
    v_and_b32 v59, 0xffff0000, v81
    v_mul_f32 v28, 0x3b000000, v28
    v_mov_b32 v36, 0x3727c5ac
    v_lshlrev_b32 v60, 16, v82
    v_and_b32 v61, 0xffff0000, v82
    v_fmac_f32 v36, 0x3b000000, v32
    v_lshlrev_b32 v62, 16, v83
    v_fma_f32 v36, -v28, v28, v36
    v_and_b32 v63, 0xffff0000, v83
    v_max_f32 v36, 0x3727c5ac, v36
    v_lshlrev_b32 v64, 16, v84
    v_rsq_f32 v36, v36
    v_and_b32 v65, 0xffff0000, v84
    v_lshlrev_b32 v66, 16, v85
    v_and_b32 v67, 0xffff0000, v85
    v_lshlrev_b32 v68, 16, v86
    v_and_b32 v69, 0xffff0000, v86
    v_lshlrev_b32 v70, 16, v87
    v_and_b32 v71, 0xffff0000, v87
    v_mul_f32 v37, v28, v36
    v_fma_f32 v40, v40, v36, -v37
    v_fma_f32 v41, v41, v36, -v37
    v_fma_f32 v42, v42, v36, -v37
    v_fma_f32 v43, v43, v36, -v37
    v_fma_f32 v44, v44, v36, -v37
    v_fma_f32 v45, v45, v36, -v37
    v_fma_f32 v46, v46, v36, -v37
    v_fma_f32 v47, v47, v36, -v37
    v_cvt_pk_bf16_f32 v72, v40, v41
    v_cvt_pk_bf16_f32 v73, v42, v43
    v_cvt_pk_bf16_f32 v74, v44, v45
    v_cvt_pk_bf16_f32 v75, v46, v47
    ds_write_b128 v18, v[72:75] offset:0
    v_fma_f32 v48, v48, v36, -v37
    v_fma_f32 v49, v49, v36, -v37
    v_fma_f32 v50, v50, v36, -v37
    v_fma_f32 v51, v51, v36, -v37
    v_fma_f32 v52, v52, v36, -v37
    v_fma_f32 v53, v53, v36, -v37
    v_fma_f32 v54, v54, v36, -v37
    v_fma_f32 v55, v55, v36, -v37
    v_cvt_pk_bf16_f32 v76, v48, v49
    v_cvt_pk_bf16_f32 v77, v50, v51
    v_cvt_pk_bf16_f32 v78, v52, v53
    v_cvt_pk_bf16_f32 v79, v54, v55
    ds_write_b128 v18, v[76:79] offset:8192
    v_fma_f32 v56, v56, v36, -v37
    v_fma_f32 v57, v57, v36, -v37
    v_fma_f32 v58, v58, v36, -v37
    v_fma_f32 v59, v59, v36, -v37
    v_fma_f32 v60, v60, v36, -v37
    v_fma_f32 v61, v61, v36, -v37
    v_fma_f32 v62, v62, v36, -v37
    v_fma_f32 v63, v63, v36, -v37
    v_cvt_pk_bf16_f32 v80, v56, v57
    v_cvt_pk_bf16_f32 v81, v58, v59
    v_cvt_pk_bf16_f32 v82, v60, v61
    v_cvt_pk_bf16_f32 v83, v62, v63
    ds_write_b128 v18, v[80:83] offset:16384
    v_fma_f32 v64, v64, v36, -v37
    v_fma_f32 v65, v65, v36, -v37
    v_fma_f32 v66, v66, v36, -v37
    v_fma_f32 v67, v67, v36, -v37
    v_fma_f32 v68, v68, v36, -v37
    v_fma_f32 v69, v69, v36, -v37
    v_fma_f32 v70, v70, v36, -v37
    v_fma_f32 v71, v71, v36, -v37
    v_cvt_pk_bf16_f32 v84, v64, v65
    v_cvt_pk_bf16_f32 v85, v66, v67
    v_cvt_pk_bf16_f32 v86, v68, v69
    v_cvt_pk_bf16_f32 v87, v70, v71
    ds_write_b128 v18, v[84:87] offset:24576
    s_waitcnt vmcnt(0)
    s_mov_b32 s72, 0x3f803f80
    v_dot2_f32_bf16 v28, v104, s72, 0
    v_dot2_f32_bf16 v32, v104, v104, 0
    v_dot2_f32_bf16 v29, v105, s72, 0
    v_dot2_f32_bf16 v33, v105, v105, 0
    v_dot2_f32_bf16 v30, v106, s72, 0
    v_dot2_f32_bf16 v34, v106, v106, 0
    v_dot2_f32_bf16 v31, v107, s72, 0
    v_dot2_f32_bf16 v35, v107, v107, 0
    v_dot2_f32_bf16 v28, v108, s72, v28
    v_dot2_f32_bf16 v32, v108, v108, v32
    v_dot2_f32_bf16 v29, v109, s72, v29
    v_dot2_f32_bf16 v33, v109, v109, v33
    v_dot2_f32_bf16 v30, v110, s72, v30
    v_dot2_f32_bf16 v34, v110, v110, v34
    v_dot2_f32_bf16 v31, v111, s72, v31
    v_dot2_f32_bf16 v35, v111, v111, v35
    v_dot2_f32_bf16 v28, v112, s72, v28
    v_dot2_f32_bf16 v32, v112, v112, v32
    v_dot2_f32_bf16 v29, v113, s72, v29
    v_dot2_f32_bf16 v33, v113, v113, v33
    v_dot2_f32_bf16 v30, v114, s72, v30
    v_dot2_f32_bf16 v34, v114, v114, v34
    v_dot2_f32_bf16 v31, v115, s72, v31
    v_dot2_f32_bf16 v35, v115, v115, v35
    v_dot2_f32_bf16 v28, v116, s72, v28
    v_dot2_f32_bf16 v32, v116, v116, v32
    v_dot2_f32_bf16 v29, v117, s72, v29
    v_dot2_f32_bf16 v33, v117, v117, v33
    v_dot2_f32_bf16 v30, v118, s72, v30
    v_dot2_f32_bf16 v34, v118, v118, v34
    v_dot2_f32_bf16 v31, v119, s72, v31
    v_dot2_f32_bf16 v35, v119, v119, v35
    v_lshlrev_b32 v40, 16, v104
    v_and_b32 v41, 0xffff0000, v104
    v_lshlrev_b32 v42, 16, v105
    v_add_f32 v28, v28, v29
    v_add_f32 v30, v30, v31
    v_add_f32 v32, v32, v33
    v_add_f32 v34, v34, v35
    v_and_b32 v43, 0xffff0000, v105
    v_add_f32 v28, v28, v30
    v_add_f32 v32, v32, v34
    v_lshlrev_b32 v44, 16, v106
    v_and_b32 v45, 0xffff0000, v106
    v_add_f32_dpp v28, v28, v28 row_ror:8 row_mask:0xf bank_mask:0xf
    v_add_f32_dpp v32, v32, v32 row_ror:8 row_mask:0xf bank_mask:0xf
    v_lshlrev_b32 v46, 16, v107
    v_and_b32 v47, 0xffff0000, v107
    v_add_f32_dpp v28, v28, v28 row_ror:4 row_mask:0xf bank_mask:0xf
    v_add_f32_dpp v32, v32, v32 row_ror:4 row_mask:0xf bank_mask:0xf
    v_lshlrev_b32 v48, 16, v108
    v_and_b32 v49, 0xffff0000, v108
    v_mov_b32 v36, v28
    v_mov_b32 v37, v32
    v_lshlrev_b32 v50, 16, v109
    v_and_b32 v51, 0xffff0000, v109
    v_permlane16_swap_b32 v28, v36
    v_permlane16_swap_b32 v32, v37
    v_lshlrev_b32 v52, 16, v110
    v_add_f32 v28, v28, v36
    v_add_f32 v32, v32, v37
    v_and_b32 v53, 0xffff0000, v110
    v_lshlrev_b32 v54, 16, v111
    v_mov_b32 v36, v28
    v_mov_b32 v37, v32
    v_and_b32 v55, 0xffff0000, v111
    v_lshlrev_b32 v56, 16, v112
    v_permlane32_swap_b32 v28, v36
    v_permlane32_swap_b32 v32, v37
    v_and_b32 v57, 0xffff0000, v112
    v_add_f32 v28, v28, v36
    v_add_f32 v32, v32, v37
    v_lshlrev_b32 v58, 16, v113
    v_and_b32 v59, 0xffff0000, v113
    v_mul_f32 v28, 0x3b000000, v28
    v_mov_b32 v36, 0x3727c5ac
    v_lshlrev_b32 v60, 16, v114
    v_and_b32 v61, 0xffff0000, v114
    v_fmac_f32 v36, 0x3b000000, v32
    v_lshlrev_b32 v62, 16, v115
    v_fma_f32 v36, -v28, v28, v36
    v_and_b32 v63, 0xffff0000, v115
    v_max_f32 v36, 0x3727c5ac, v36
    v_lshlrev_b32 v64, 16, v116
    v_rsq_f32 v36, v36
    v_and_b32 v65, 0xffff0000, v116
    v_lshlrev_b32 v66, 16, v117
    v_and_b32 v67, 0xffff0000, v117
    v_lshlrev_b32 v68, 16, v118
    v_and_b32 v69, 0xffff0000, v118
    v_lshlrev_b32 v70, 16, v119
    v_and_b32 v71, 0xffff0000, v119
    v_mul_f32 v37, v28, v36
    v_fma_f32 v40, v40, v36, -v37
    v_fma_f32 v41, v41, v36, -v37
    v_fma_f32 v42, v42, v36, -v37
    v_fma_f32 v43, v43, v36, -v37
    v_fma_f32 v44, v44, v36, -v37
    v_fma_f32 v45, v45, v36, -v37
    v_fma_f32 v46, v46, v36, -v37
    v_fma_f32 v47, v47, v36, -v37
    v_cvt_pk_bf16_f32 v104, v40, v41
    v_cvt_pk_bf16_f32 v105, v42, v43
    v_cvt_pk_bf16_f32 v106, v44, v45
    v_cvt_pk_bf16_f32 v107, v46, v47
    ds_write_b128 v18, v[104:107] offset:32768
    v_fma_f32 v48, v48, v36, -v37
    v_fma_f32 v49, v49, v36, -v37
    v_fma_f32 v50, v50, v36, -v37
    v_fma_f32 v51, v51, v36, -v37
    v_fma_f32 v52, v52, v36, -v37
    v_fma_f32 v53, v53, v36, -v37
    v_fma_f32 v54, v54, v36, -v37
    v_fma_f32 v55, v55, v36, -v37
    v_cvt_pk_bf16_f32 v108, v48, v49
    v_cvt_pk_bf16_f32 v109, v50, v51
    v_cvt_pk_bf16_f32 v110, v52, v53
    v_cvt_pk_bf16_f32 v111, v54, v55
    ds_write_b128 v18, v[108:111] offset:40960
    v_fma_f32 v56, v56, v36, -v37
    v_fma_f32 v57, v57, v36, -v37
    v_fma_f32 v58, v58, v36, -v37
    v_fma_f32 v59, v59, v36, -v37
    v_fma_f32 v60, v60, v36, -v37
    v_fma_f32 v61, v61, v36, -v37
    v_fma_f32 v62, v62, v36, -v37
    v_fma_f32 v63, v63, v36, -v37
    v_cvt_pk_bf16_f32 v112, v56, v57
    v_cvt_pk_bf16_f32 v113, v58, v59
    v_cvt_pk_bf16_f32 v114, v60, v61
    v_cvt_pk_bf16_f32 v115, v62, v63
    ds_write_b128 v18, v[112:115] offset:49152
    v_fma_f32 v64, v64, v36, -v37
    v_fma_f32 v65, v65, v36, -v37
    v_fma_f32 v66, v66, v36, -v37
    v_fma_f32 v67, v67, v36, -v37
    v_fma_f32 v68, v68, v36, -v37
    v_fma_f32 v69, v69, v36, -v37
    v_fma_f32 v70, v70, v36, -v37
    v_fma_f32 v71, v71, v36, -v37
    v_cvt_pk_bf16_f32 v116, v64, v65
    v_cvt_pk_bf16_f32 v117, v66, v67
    v_cvt_pk_bf16_f32 v118, v68, v69
    v_cvt_pk_bf16_f32 v119, v70, v71
    ds_write_b128 v18, v[116:119] offset:57344
    s_waitcnt lgkmcnt(0)
    s_barrier
    ds_read_b64_tr_b16 v[88:89], v3 offset:0
    ds_read_b64_tr_b16 v[90:91], v3 offset:256
    ds_read_b128 v[56:59], v7 offset:0
    ds_read_b128 v[60:63], v7 offset:32768
    ds_read_b64_tr_b16 v[92:93], v3 offset:1024
    ds_read_b64_tr_b16 v[94:95], v3 offset:1280
    ds_read_b128 v[64:67], v8 offset:1024
    ds_read_b128 v[68:71], v8 offset:33792
    ds_read_b64_tr_b16 v[96:97], v3 offset:2048
    ds_read_b64_tr_b16 v[98:99], v3 offset:2304
    ds_read_b128 v[72:75], v9 offset:2048
    ds_read_b128 v[76:79], v9 offset:34816
    s_waitcnt lgkmcnt(8)
    v_mfma_f32_32x32x16_bf16 v[104:119], v[88:91], v[56:59], 0
    v_mfma_f32_32x32x16_bf16 v[120:135], v[88:91], v[60:63], 0
    s_add_u32 m0, s66, 0
    s_add_u32 s75, s69, 688128
    buffer_load_dwordx4 v1, s[32:35], s75 offen lds
    ds_read_b64_tr_b16 v[100:101], v3 offset:3072
    ds_read_b64_tr_b16 v[102:103], v3 offset:3328
    ds_read_b128 v[80:83], v10 offset:3072
    ds_read_b128 v[84:87], v10 offset:35840
    s_waitcnt lgkmcnt(8)
    v_mfma_f32_32x32x16_bf16 v[104:119], v[92:95], v[64:67], v[104:119]
    v_mfma_f32_32x32x16_bf16 v[120:135], v[92:95], v[68:71], v[120:135]
    s_add_u32 m0, s66, 1024
    s_add_u32 s75, s69, 745472
    buffer_load_dwordx4 v1, s[32:35], s75 offen lds
    ds_read_b64_tr_b16 v[88:89], v3 offset:4096
    ds_read_b64_tr_b16 v[90:91], v3 offset:4352
    ds_read_b128 v[56:59], v7 offset:4096
    ds_read_b128 v[60:63], v7 offset:36864
    s_waitcnt lgkmcnt(8)
    v_mfma_f32_32x32x16_bf16 v[104:119], v[96:99], v[72:75], v[104:119]
    v_mfma_f32_32x32x16_bf16 v[120:135], v[96:99], v[76:79], v[120:135]
    s_add_u32 m0, s66, 2048
    s_add_u32 s75, s69, 802816
    buffer_load_dwordx4 v1, s[32:35], s75 offen lds
    ds_read_b64_tr_b16 v[92:93], v3 offset:5120
    ds_read_b64_tr_b16 v[94:95], v3 offset:5376
    ds_read_b128 v[64:67], v8 offset:5120
    ds_read_b128 v[68:71], v8 offset:37888
    s_waitcnt lgkmcnt(8)
    v_mfma_f32_32x32x16_bf16 v[104:119], v[100:103], v[80:83], v[104:119]
    v_mfma_f32_32x32x16_bf16 v[120:135], v[100:103], v[84:87], v[120:135]
    s_add_u32 m0, s66, 3072
    s_add_u32 s75, s69, 860160
    buffer_load_dwordx4 v1, s[32:35], s75 offen lds
    ds_read_b64_tr_b16 v[96:97], v3 offset:6144
    ds_read_b64_tr_b16 v[98:99], v3 offset:6400
    ds_read_b128 v[72:75], v9 offset:6144
    ds_read_b128 v[76:79], v9 offset:38912
    s_waitcnt lgkmcnt(8)
    v_mfma_f32_32x32x16_bf16 v[104:119], v[88:91], v[56:59], v[104:119]
    v_mfma_f32_32x32x16_bf16 v[120:135], v[88:91], v[60:63], v[120:135]
    s_add_u32 m0, s66, 4096
    s_nop 0
    buffer_load_dwordx4 v2, s[36:39], s70 offen lds
    ds_read_b64_tr_b16 v[100:101], v3 offset:7168
    ds_read_b64_tr_b16 v[102:103], v3 offset:7424
    ds_read_b128 v[80:83], v10 offset:7168
    ds_read_b128 v[84:87], v10 offset:39936
    s_waitcnt lgkmcnt(8)
    v_mfma_f32_32x32x16_bf16 v[104:119], v[92:95], v[64:67], v[104:119]
    v_mfma_f32_32x32x16_bf16 v[120:135], v[92:95], v[68:71], v[120:135]
    s_add_u32 m0, s66, 5120
    s_add_u32 s75, s70, 8192
    buffer_load_dwordx4 v2, s[36:39], s75 offen lds
    ds_read_b64_tr_b16 v[88:89], v3 offset:8192
    ds_read_b64_tr_b16 v[90:91], v3 offset:8448
    ds_read_b128 v[56:59], v7 offset:8192
    ds_read_b128 v[60:63], v7 offset:40960
    s_waitcnt lgkmcnt(8)
    v_mfma_f32_32x32x16_bf16 v[104:119], v[96:99], v[72:75], v[104:119]
    v_mfma_f32_32x32x16_bf16 v[120:135], v[96:99], v[76:79], v[120:135]
    s_add_u32 m0, s66, 6144
    s_add_u32 s75, s70, 16384
    buffer_load_dwordx4 v2, s[36:39], s75 offen lds
    ds_read_b64_tr_b16 v[92:93], v3 offset:9216
    ds_read_b64_tr_b16 v[94:95], v3 offset:9472
    ds_read_b128 v[64:67], v8 offset:9216
    ds_read_b128 v[68:71], v8 offset:41984
    s_waitcnt lgkmcnt(8)
    v_mfma_f32_32x32x16_bf16 v[104:119], v[100:103], v[80:83], v[104:119]
    v_mfma_f32_32x32x16_bf16 v[120:135], v[100:103], v[84:87], v[120:135]
    s_add_u32 m0, s66, 7168
    s_add_u32 s75, s70, 24576
    buffer_load_dwordx4 v2, s[36:39], s75 offen lds
    ds_read_b64_tr_b16 v[96:97], v3 offset:10240
    ds_read_b64_tr_b16 v[98:99], v3 offset:10496
    ds_read_b128 v[72:75], v9 offset:10240
    ds_read_b128 v[76:79], v9 offset:43008
    s_waitcnt lgkmcnt(8)
    v_mfma_f32_32x32x16_bf16 v[104:119], v[88:91], v[56:59], v[104:119]
    v_mfma_f32_32x32x16_bf16 v[120:135], v[88:91], v[60:63], v[120:135]
    s_add_u32 m0, s66, 8192
    s_add_u32 s75, s70, 32768
    buffer_load_dwordx4 v2, s[36:39], s75 offen lds
    ds_read_b64_tr_b16 v[100:101], v3 offset:11264
    ds_read_b64_tr_b16 v[102:103], v3 offset:11520
    ds_read_b128 v[80:83], v10 offset:11264
    ds_read_b128 v[84:87], v10 offset:44032
    s_waitcnt lgkmcnt(8)
    v_mfma_f32_32x32x16_bf16 v[104:119], v[92:95], v[64:67], v[104:119]
    v_mfma_f32_32x32x16_bf16 v[120:135], v[92:95], v[68:71], v[120:135]
    s_add_u32 m0, s66, 9216
    s_add_u32 s75, s70, 40960
    buffer_load_dwordx4 v2, s[36:39], s75 offen lds
    s_waitcnt vmcnt(9)
    ds_read_b64_tr_b16 v[88:89], v3 offset:0
    ds_read_b64_tr_b16 v[90:91], v3 offset:256
    ds_read_b128 v[56:59], v7 offset:12288
    ds_read_b128 v[60:63], v7 offset:45056
    s_waitcnt lgkmcnt(8)
    v_mfma_f32_32x32x16_bf16 v[104:119], v[96:99], v[72:75], v[104:119]
    v_mfma_f32_32x32x16_bf16 v[120:135], v[96:99], v[76:79], v[120:135]
    s_add_u32 m0, s66, 10240
    s_add_u32 s75, s70, 49152
    buffer_load_dwordx4 v2, s[36:39], s75 offen lds
    s_waitcnt vmcnt(9)
    ds_read_b64_tr_b16 v[92:93], v3 offset:1024
    ds_read_b64_tr_b16 v[94:95], v3 offset:1280
    ds_read_b128 v[64:67], v8 offset:13312
    ds_read_b128 v[68:71], v8 offset:46080
    s_waitcnt lgkmcnt(8)
    v_mfma_f32_32x32x16_bf16 v[104:119], v[100:103], v[80:83], v[104:119]
    v_mfma_f32_32x32x16_bf16 v[120:135], v[100:103], v[84:87], v[120:135]
    s_add_u32 m0, s66, 11264
    s_add_u32 s75, s70, 57344
    buffer_load_dwordx4 v2, s[36:39], s75 offen lds
    s_waitcnt vmcnt(9)
    ds_read_b64_tr_b16 v[96:97], v3 offset:2048
    ds_read_b64_tr_b16 v[98:99], v3 offset:2304
    ds_read_b128 v[72:75], v9 offset:14336
    ds_read_b128 v[76:79], v9 offset:47104
    s_waitcnt lgkmcnt(8)
    v_mfma_f32_32x32x16_bf16 v[104:119], v[88:91], v[56:59], v[104:119]
    v_mfma_f32_32x32x16_bf16 v[120:135], v[88:91], v[60:63], v[120:135]
    s_waitcnt vmcnt(8)
    ds_read_b64_tr_b16 v[100:101], v3 offset:3072
    ds_read_b64_tr_b16 v[102:103], v3 offset:3328
    ds_read_b128 v[80:83], v10 offset:15360
    ds_read_b128 v[84:87], v10 offset:48128
    s_waitcnt lgkmcnt(8)
    v_mfma_f32_32x32x16_bf16 v[104:119], v[92:95], v[64:67], v[104:119]
    v_mfma_f32_32x32x16_bf16 v[120:135], v[92:95], v[68:71], v[120:135]
    s_waitcnt lgkmcnt(4)
    v_mfma_f32_32x32x16_bf16 v[104:119], v[96:99], v[72:75], v[104:119]
    v_mfma_f32_32x32x16_bf16 v[120:135], v[96:99], v[76:79], v[120:135]
    s_waitcnt lgkmcnt(0)
    v_mfma_f32_32x32x16_bf16 v[104:119], v[100:103], v[80:83], v[104:119]
    v_mfma_f32_32x32x16_bf16 v[120:135], v[100:103], v[84:87], v[120:135]
    s_cmp_eq_u32 s56, 0
    s_cbranch_scc0 L_KH1
    s_nop 9
    ds_write_b128 v24, v[120:123] offset:0
    ds_write_b128 v24, v[124:127] offset:1024
    ds_write_b128 v24, v[128:131] offset:2048
    ds_write_b128 v24, v[132:135] offset:3072
    s_branch L_KHW
L_KH1:
    s_nop 8
    ds_write_b128 v24, v[104:107] offset:0
    ds_write_b128 v24, v[108:111] offset:1024
    ds_write_b128 v24, v[112:115] offset:2048
    ds_write_b128 v24, v[116:119] offset:3072
L_KHW:
    s_waitcnt lgkmcnt(0)
    s_barrier
    ds_read_b128 v[56:59], v6 offset:0
    ds_read_b128 v[60:63], v6 offset:1024
    ds_read_b128 v[64:67], v6 offset:2048
    ds_read_b128 v[68:71], v6 offset:3072
    s_waitcnt lgkmcnt(0)
    s_cmp_eq_u32 s56, 0
    s_cbranch_scc0 L_KH1b
    v_add_f32 v40, v104, v56
    v_add_f32 v41, v105, v57
    v_add_f32 v42, v106, v58
    v_add_f32 v43, v107, v59
    v_add_f32 v44, v108, v60
    v_add_f32 v45, v109, v61
    v_add_f32 v46, v110, v62
    v_add_f32 v47, v111, v63
    v_add_f32 v48, v112, v64
    v_add_f32 v49, v113, v65
    v_add_f32 v50, v114, v66
    v_add_f32 v51, v115, v67
    v_add_f32 v52, v116, v68
    v_add_f32 v53, v117, v69
    v_add_f32 v54, v118, v70
    v_add_f32 v55, v119, v71
    s_branch L_KHA
L_KH1b:
    v_add_f32 v40, v120, v56
    v_add_f32 v41, v121, v57
    v_add_f32 v42, v122, v58
    v_add_f32 v43, v123, v59
    v_add_f32 v44, v124, v60
    v_add_f32 v45, v125, v61
    v_add_f32 v46, v126, v62
    v_add_f32 v47, v127, v63
    v_add_f32 v48, v128, v64
    v_add_f32 v49, v129, v65
    v_add_f32 v50, v130, v66
    v_add_f32 v51, v131, v67
    v_add_f32 v52, v132, v68
    v_add_f32 v53, v133, v69
    v_add_f32 v54, v134, v70
    v_add_f32 v55, v135, v71
L_KHA:
    s_mov_b32 s72, 0xbdd2d3e8
    s_mov_b32 s73, 0xbdd2d3e8
    v_mov_b32 v36, 0xc0135761
    v_mov_b32 v37, 0xc0135761
    v_pk_mul_f32 v[88:89], v[40:41], v[40:41]
    v_pk_mul_f32 v[90:91], v[42:43], v[42:43]
    v_pk_mul_f32 v[92:93], v[44:45], v[44:45]
    v_pk_mul_f32 v[94:95], v[46:47], v[46:47]
    v_pk_mul_f32 v[96:97], v[48:49], v[48:49]
    v_pk_mul_f32 v[98:99], v[50:51], v[50:51]
    v_pk_mul_f32 v[100:101], v[52:53], v[52:53]
    v_pk_mul_f32 v[102:103], v[54:55], v[54:55]
    s_add_u32 m0, s59, 0
    s_add_u32 s75, s70, 98304
    buffer_load_dwordx4 v2, s[36:39], s75 offen lds
    v_pk_fma_f32 v[88:89], v[88:89], s[72:73], v[36:37]
    v_pk_fma_f32 v[90:91], v[90:91], s[72:73], v[36:37]
    v_pk_fma_f32 v[92:93], v[92:93], s[72:73], v[36:37]
    v_pk_fma_f32 v[94:95], v[94:95], s[72:73], v[36:37]
    v_pk_fma_f32 v[96:97], v[96:97], s[72:73], v[36:37]
    v_pk_fma_f32 v[98:99], v[98:99], s[72:73], v[36:37]
    v_pk_fma_f32 v[100:101], v[100:101], s[72:73], v[36:37]
    v_pk_fma_f32 v[102:103], v[102:103], s[72:73], v[36:37]
    s_add_u32 m0, s59, 1024
    s_add_u32 s75, s70, 106496
    buffer_load_dwordx4 v2, s[36:39], s75 offen lds
    v_pk_mul_f32 v[88:89], v[88:89], v[40:41]
    v_pk_mul_f32 v[90:91], v[90:91], v[42:43]
    v_pk_mul_f32 v[92:93], v[92:93], v[44:45]
    v_pk_mul_f32 v[94:95], v[94:95], v[46:47]
    v_pk_mul_f32 v[96:97], v[96:97], v[48:49]
    v_pk_mul_f32 v[98:99], v[98:99], v[50:51]
    v_pk_mul_f32 v[100:101], v[100:101], v[52:53]
    v_pk_mul_f32 v[102:103], v[102:103], v[54:55]
    s_add_u32 m0, s59, 2048
    s_add_u32 s75, s70, 114688
    buffer_load_dwordx4 v2, s[36:39], s75 offen lds
    v_exp_f32 v88, v88
    v_exp_f32 v89, v89
    v_exp_f32 v90, v90
    v_exp_f32 v91, v91
    v_exp_f32 v92, v92
    v_exp_f32 v93, v93
    v_exp_f32 v94, v94
    v_exp_f32 v95, v95
    v_exp_f32 v96, v96
    v_exp_f32 v97, v97
    v_exp_f32 v98, v98
    v_exp_f32 v99, v99
    v_exp_f32 v100, v100
    v_exp_f32 v101, v101
    v_exp_f32 v102, v102
    v_exp_f32 v103, v103
    s_add_u32 m0, s59, 3072
    s_add_u32 s75, s70, 122880
    buffer_load_dwordx4 v2, s[36:39], s75 offen lds
    v_pk_add_f32 v[88:89], v[88:89], 1.0 op_sel_hi:[1,0]
    v_pk_add_f32 v[90:91], v[90:91], 1.0 op_sel_hi:[1,0]
    v_pk_add_f32 v[92:93], v[92:93], 1.0 op_sel_hi:[1,0]
    v_pk_add_f32 v[94:95], v[94:95], 1.0 op_sel_hi:[1,0]
    v_pk_add_f32 v[96:97], v[96:97], 1.0 op_sel_hi:[1,0]
    v_pk_add_f32 v[98:99], v[98:99], 1.0 op_sel_hi:[1,0]
    v_pk_add_f32 v[100:101], v[100:101], 1.0 op_sel_hi:[1,0]
    v_pk_add_f32 v[102:103], v[102:103], 1.0 op_sel_hi:[1,0]
    s_add_u32 m0, s59, 4096
    s_add_u32 s75, s70, 131072
    buffer_load_dwordx4 v2, s[36:39], s75 offen lds
    v_rcp_f32 v88, v88
    v_rcp_f32 v89, v89
    v_rcp_f32 v90, v90
    v_rcp_f32 v91, v91
    v_rcp_f32 v92, v92
    v_rcp_f32 v93, v93
    v_rcp_f32 v94, v94
    v_rcp_f32 v95, v95
    v_rcp_f32 v96, v96
    v_rcp_f32 v97, v97
    v_rcp_f32 v98, v98
    v_rcp_f32 v99, v99
    v_rcp_f32 v100, v100
    v_rcp_f32 v101, v101
    v_rcp_f32 v102, v102
    v_rcp_f32 v103, v103
    s_add_u32 m0, s59, 5120
    s_add_u32 s75, s70, 139264
    buffer_load_dwordx4 v2, s[36:39], s75 offen lds
    s_add_u32 m0, s59, 6144
    s_add_u32 s75, s70, 147456
    buffer_load_dwordx4 v2, s[36:39], s75 offen lds
    s_add_u32 m0, s59, 7168
    s_add_u32 s75, s70, 155648
    buffer_load_dwordx4 v2, s[36:39], s75 offen lds
    v_pk_mul_f32 v[40:41], v[40:41], v[88:89]
    v_pk_mul_f32 v[42:43], v[42:43], v[90:91]
    v_pk_mul_f32 v[44:45], v[44:45], v[92:93]
    v_pk_mul_f32 v[46:47], v[46:47], v[94:95]
    v_pk_mul_f32 v[48:49], v[48:49], v[96:97]
    v_pk_mul_f32 v[50:51], v[50:51], v[98:99]
    v_pk_mul_f32 v[52:53], v[52:53], v[100:101]
    v_pk_mul_f32 v[54:55], v[54:55], v[102:103]
    v_cvt_pk_bf16_f32 v136, v40, v41
    v_cvt_pk_bf16_f32 v137, v42, v43
    v_cvt_pk_bf16_f32 v138, v44, v45
    v_cvt_pk_bf16_f32 v139, v46, v47
    v_cvt_pk_bf16_f32 v140, v48, v49
    v_cvt_pk_bf16_f32 v141, v50, v51
    v_cvt_pk_bf16_f32 v142, v52, v53
    v_cvt_pk_bf16_f32 v143, v54, v55
    v_permlane32_swap_b32 v136, v138
    v_permlane32_swap_b32 v137, v139
    v_permlane32_swap_b32 v140, v142
    v_permlane32_swap_b32 v141, v143
    buffer_store_dwordx4 v[136:139], v23, s[52:55], s57 offen offset:0 sc1
    buffer_store_dwordx4 v[140:143], v23, s[52:55], s57 offen offset:1024 sc1
    s_waitcnt vmcnt(0)
    s_barrier
    s_branch L_JOINB
L_IDLECU:
    s_barrier
    s_barrier
    s_barrier
    s_add_u32 m0, s66, 4096
    s_nop 0
    buffer_load_dwordx4 v2, s[36:39], s70 offen lds
    s_add_u32 m0, s66, 5120
    s_add_u32 s75, s70, 8192
    buffer_load_dwordx4 v2, s[36:39], s75 offen lds
    s_add_u32 m0, s66, 6144
    s_add_u32 s75, s70, 16384
    buffer_load_dwordx4 v2, s[36:39], s75 offen lds
    s_add_u32 m0, s66, 7168
    s_add_u32 s75, s70, 24576
    buffer_load_dwordx4 v2, s[36:39], s75 offen lds
    s_add_u32 m0, s66, 8192
    s_add_u32 s75, s70, 32768
    buffer_load_dwordx4 v2, s[36:39], s75 offen lds
    s_add_u32 m0, s66, 9216
    s_add_u32 s75, s70, 40960
    buffer_load_dwordx4 v2, s[36:39], s75 offen lds
    s_add_u32 m0, s66, 10240
    s_add_u32 s75, s70, 49152
    buffer_load_dwordx4 v2, s[36:39], s75 offen lds
    s_add_u32 m0, s66, 11264
    s_add_u32 s75, s70, 57344
    buffer_load_dwordx4 v2, s[36:39], s75 offen lds
    s_add_u32 m0, s59, 0
    s_add_u32 s75, s70, 98304
    buffer_load_dwordx4 v2, s[36:39], s75 offen lds
    s_add_u32 m0, s59, 1024
    s_add_u32 s75, s70, 106496
    buffer_load_dwordx4 v2, s[36:39], s75 offen lds
    s_add_u32 m0, s59, 2048
    s_add_u32 s75, s70, 114688
    buffer_load_dwordx4 v2, s[36:39], s75 offen lds
    s_add_u32 m0, s59, 3072
    s_add_u32 s75, s70, 122880
    buffer_load_dwordx4 v2, s[36:39], s75 offen lds
    s_add_u32 m0, s59, 4096
    s_add_u32 s75, s70, 131072
    buffer_load_dwordx4 v2, s[36:39], s75 offen lds
    s_add_u32 m0, s59, 5120
    s_add_u32 s75, s70, 139264
    buffer_load_dwordx4 v2, s[36:39], s75 offen lds
    s_add_u32 m0, s59, 6144
    s_add_u32 s75, s70, 147456
    buffer_load_dwordx4 v2, s[36:39], s75 offen lds
    s_add_u32 m0, s59, 7168
    s_add_u32 s75, s70, 155648
    buffer_load_dwordx4 v2, s[36:39], s75 offen lds
    s_waitcnt vmcnt(0)
    s_barrier
L_JOINB:
    s_add_u32 m0, s66, 0
    s_add_u32 s75, s70, 65536
    buffer_load_dwordx4 v2, s[36:39], s75 offen lds
    s_add_u32 m0, s66, 1024
    s_add_u32 s75, s70, 73728
    buffer_load_dwordx4 v2, s[36:39], s75 offen lds
    s_add_u32 m0, s66, 2048
    s_add_u32 s75, s70, 81920
    buffer_load_dwordx4 v2, s[36:39], s75 offen lds
    s_add_u32 m0, s66, 3072
    s_add_u32 s75, s70, 90112
    buffer_load_dwordx4 v2, s[36:39], s75 offen lds
    s_barrier
    s_cmp_eq_u32 s63, 0
    s_cbranch_scc1 L_SLOW5
    buffer_load_dwordx4 v[40:43], v11, s[52:55], s58 offen
    s_add_u32 s73, s58, 1024
    buffer_load_dwordx4 v[44:47], v11, s[52:55], s73 offen
    s_add_u32 s73, s58, 2048
    buffer_load_dwordx4 v[48:51], v11, s[52:55], s73 offen
    s_add_u32 s73, s58, 3072
    buffer_load_dwordx4 v[52:55], v11, s[52:55], s73 offen
    s_add_u32 s73, s58, 4096
    buffer_load_dwordx4 v[56:59], v11, s[52:55], s73 offen
    s_add_u32 s73, s58, 5120
    buffer_load_dwordx4 v[60:63], v11, s[52:55], s73 offen
    s_add_u32 s73, s58, 6144
    buffer_load_dwordx4 v[64:67], v11, s[52:55], s73 offen
    s_add_u32 s73, s58, 7168
    buffer_load_dwordx4 v[68:71], v11, s[52:55], s73 offen
    s_add_u32 s73, s58, 8192
    buffer_load_dwordx4 v[72:75], v11, s[52:55], s73 offen
    s_add_u32 s73, s58, 9216
    buffer_load_dwordx4 v[76:79], v11, s[52:55], s73 offen
    s_add_u32 s73, s58, 10240
    buffer_load_dwordx4 v[80:83], v11, s[52:55], s73 offen
    s_add_u32 s73, s58, 11264
    buffer_load_dwordx4 v[84:87], v11, s[52:55], s73 offen
    s_add_u32 s73, s58, 12288
    buffer_load_dwordx4 v[88:91], v11, s[52:55], s73 offen
    s_add_u32 s73, s58, 13312
    buffer_load_dwordx4 v[92:95], v11, s[52:55], s73 offen
    s_branch L_DONE5
L_SLOW5:
    buffer_load_dwordx4 v[40:43], v11, s[52:55], s58 offen sc1
    s_add_u32 s73, s58, 1024
    buffer_load_dwordx4 v[44:47], v11, s[52:55], s73 offen sc1
    s_add_u32 s73, s58, 2048
    buffer_load_dwordx4 v[48:51], v11, s[52:55], s73 offen sc1
    s_add_u32 s73, s58, 3072
    buffer_load_dwordx4 v[52:55], v11, s[52:55], s73 offen sc1
    s_add_u32 s73, s58, 4096
    buffer_load_dwordx4 v[56:59], v11, s[52:55], s73 offen sc1
    s_add_u32 s73, s58, 5120
    buffer_load_dwordx4 v[60:63], v11, s[52:55], s73 offen sc1
    s_add_u32 s73, s58, 6144
    buffer_load_dwordx4 v[64:67], v11, s[52:55], s73 offen sc1
    s_add_u32 s73, s58, 7168
    buffer_load_dwordx4 v[68:71], v11, s[52:55], s73 offen sc1
    s_add_u32 s73, s58, 8192
    buffer_load_dwordx4 v[72:75], v11, s[52:55], s73 offen sc1
    s_add_u32 s73, s58, 9216
    buffer_load_dwordx4 v[76:79], v11, s[52:55], s73 offen sc1
    s_add_u32 s73, s58, 10240
    buffer_load_dwordx4 v[80:83], v11, s[52:55], s73 offen sc1
    s_add_u32 s73, s58, 11264
    buffer_load_dwordx4 v[84:87], v11, s[52:55], s73 offen sc1
    s_add_u32 s73, s58, 12288
    buffer_load_dwordx4 v[88:91], v11, s[52:55], s73 offen sc1
    s_add_u32 s73, s58, 13312
    buffer_load_dwordx4 v[92:95], v11, s[52:55], s73 offen sc1
L_DONE5:
    ds_read_b64_tr_b16 v[136:137], v5 offset:4096
    ds_read_b64_tr_b16 v[138:139], v5 offset:4352
    ds_read_b64_tr_b16 v[140:141], v5 offset:4608
    ds_read_b64_tr_b16 v[142:143], v5 offset:4864
    ds_read_b64_tr_b16 v[144:145], v5 offset:6144
    ds_read_b64_tr_b16 v[146:147], v5 offset:6400
    ds_read_b64_tr_b16 v[148:149], v5 offset:6656
    ds_read_b64_tr_b16 v[150:151], v5 offset:6912
    s_waitcnt lgkmcnt(4)
    s_waitcnt vmcnt(13)
    v_mfma_f32_32x32x16_bf16 v[104:119], v[136:139], v[40:43], 0
    v_mfma_f32_32x32x16_bf16 v[120:135], v[140:143], v[40:43], 0
    s_add_u32 m0, s66, 4096
    s_add_u32 s75, s70, 163840
    buffer_load_dwordx4 v2, s[36:39], s75 offen lds
    s_add_u32 m0, s66, 5120
    s_add_u32 s75, s70, 172032
    buffer_load_dwordx4 v2, s[36:39], s75 offen lds
    ds_read_b64_tr_b16 v[96:97], v5 offset:8192
    ds_read_b64_tr_b16 v[98:99], v5 offset:8448
    ds_read_b64_tr_b16 v[100:101], v5 offset:8704
    ds_read_b64_tr_b16 v[102:103], v5 offset:8960
    s_waitcnt lgkmcnt(4)
    s_waitcnt vmcnt(14)
    v_mfma_f32_32x32x16_bf16 v[104:119], v[144:147], v[44:47], v[104:119]
    v_mfma_f32_32x32x16_bf16 v[120:135], v[148:151], v[44:47], v[120:135]
    s_add_u32 m0, s66, 6144
    s_add_u32 s75, s70, 180224
    buffer_load_dwordx4 v2, s[36:39], s75 offen lds
    s_add_u32 m0, s66, 7168
    s_add_u32 s75, s70, 188416
    buffer_load_dwordx4 v2, s[36:39], s75 offen lds
    ds_read_b64_tr_b16 v[136:137], v5 offset:10240
    ds_read_b64_tr_b16 v[138:139], v5 offset:10496
    ds_read_b64_tr_b16 v[140:141], v5 offset:10752
    ds_read_b64_tr_b16 v[142:143], v5 offset:11008
    s_waitcnt lgkmcnt(4)
    s_waitcnt vmcnt(15)
    v_mfma_f32_32x32x16_bf16 v[104:119], v[96:99], v[48:51], v[104:119]
    v_mfma_f32_32x32x16_bf16 v[120:135], v[100:103], v[48:51], v[120:135]
    s_add_u32 m0, s66, 8192
    s_add_u32 s75, s70, 196608
    buffer_load_dwordx4 v2, s[36:39], s75 offen lds
    s_add_u32 m0, s66, 9216
    s_add_u32 s75, s70, 204800
    buffer_load_dwordx4 v2, s[36:39], s75 offen lds
    ds_read_b64_tr_b16 v[144:145], v5 offset:0
    ds_read_b64_tr_b16 v[146:147], v5 offset:256
    ds_read_b64_tr_b16 v[148:149], v5 offset:512
    ds_read_b64_tr_b16 v[150:151], v5 offset:768
    s_waitcnt lgkmcnt(4)
    s_waitcnt vmcnt(16)
    v_mfma_f32_32x32x16_bf16 v[104:119], v[136:139], v[52:55], v[104:119]
    v_mfma_f32_32x32x16_bf16 v[120:135], v[140:143], v[52:55], v[120:135]
    s_add_u32 m0, s66, 10240
    s_add_u32 s75, s70, 212992
    buffer_load_dwordx4 v2, s[36:39], s75 offen lds
    s_add_u32 m0, s66, 11264
    s_add_u32 s75, s70, 221184
    buffer_load_dwordx4 v2, s[36:39], s75 offen lds
    ds_read_b64_tr_b16 v[96:97], v5 offset:2048
    ds_read_b64_tr_b16 v[98:99], v5 offset:2304
    ds_read_b64_tr_b16 v[100:101], v5 offset:2560
    ds_read_b64_tr_b16 v[102:103], v5 offset:2816
    s_waitcnt lgkmcnt(4)
    s_waitcnt vmcnt(17)
    v_mfma_f32_32x32x16_bf16 v[104:119], v[144:147], v[56:59], v[104:119]
    v_mfma_f32_32x32x16_bf16 v[120:135], v[148:151], v[56:59], v[120:135]
    ds_read_b64_tr_b16 v[136:137], v39 offset:0
    ds_read_b64_tr_b16 v[138:139], v39 offset:256
    ds_read_b64_tr_b16 v[140:141], v39 offset:512
    ds_read_b64_tr_b16 v[142:143], v39 offset:768
    s_waitcnt lgkmcnt(4)
    s_waitcnt vmcnt(16)
    v_mfma_f32_32x32x16_bf16 v[104:119], v[96:99], v[60:63], v[104:119]
    v_mfma_f32_32x32x16_bf16 v[120:135], v[100:103], v[60:63], v[120:135]
    ds_read_b64_tr_b16 v[144:145], v39 offset:2048
    ds_read_b64_tr_b16 v[146:147], v39 offset:2304
    ds_read_b64_tr_b16 v[148:149], v39 offset:2560
    ds_read_b64_tr_b16 v[150:151], v39 offset:2816
    s_waitcnt lgkmcnt(4)
    s_waitcnt vmcnt(15)
    v_mfma_f32_32x32x16_bf16 v[104:119], v[136:139], v[64:67], v[104:119]
    v_mfma_f32_32x32x16_bf16 v[120:135], v[140:143], v[64:67], v[120:135]
    ds_read_b64_tr_b16 v[96:97], v39 offset:4096
    ds_read_b64_tr_b16 v[98:99], v39 offset:4352
    ds_read_b64_tr_b16 v[100:101], v39 offset:4608
    ds_read_b64_tr_b16 v[102:103], v39 offset:4864
    s_waitcnt lgkmcnt(4)
    s_waitcnt vmcnt(14)
    v_mfma_f32_32x32x16_bf16 v[104:119], v[144:147], v[68:71], v[104:119]
    v_mfma_f32_32x32x16_bf16 v[120:135], v[148:151], v[68:71], v[120:135]
    ds_read_b64_tr_b16 v[136:137], v39 offset:6144
    ds_read_b64_tr_b16 v[138:139], v39 offset:6400
    ds_read_b64_tr_b16 v[140:141], v39 offset:6656
    ds_read_b64_tr_b16 v[142:143], v39 offset:6912
    s_waitcnt lgkmcnt(4)
    s_waitcnt vmcnt(13)
    v_mfma_f32_32x32x16_bf16 v[104:119], v[96:99], v[72:75], v[104:119]
    v_mfma_f32_32x32x16_bf16 v[120:135], v[100:103], v[72:75], v[120:135]
    s_waitcnt vmcnt(6)
    ds_read_b64_tr_b16 v[144:145], v5 offset:4096
    ds_read_b64_tr_b16 v[146:147], v5 offset:4352
    ds_read_b64_tr_b16 v[148:149], v5 offset:4608
    ds_read_b64_tr_b16 v[150:151], v5 offset:4864
    s_waitcnt lgkmcnt(4)
    v_mfma_f32_32x32x16_bf16 v[104:119], v[136:139], v[76:79], v[104:119]
    v_mfma_f32_32x32x16_bf16 v[120:135], v[140:143], v[76:79], v[120:135]
    s_waitcnt vmcnt(4)
    ds_read_b64_tr_b16 v[96:97], v5 offset:6144
    ds_read_b64_tr_b16 v[98:99], v5 offset:6400
    ds_read_b64_tr_b16 v[100:101], v5 offset:6656
    ds_read_b64_tr_b16 v[102:103], v5 offset:6912
    s_waitcnt lgkmcnt(4)
    v_mfma_f32_32x32x16_bf16 v[104:119], v[144:147], v[80:83], v[104:119]
    v_mfma_f32_32x32x16_bf16 v[120:135], v[148:151], v[80:83], v[120:135]
    s_waitcnt vmcnt(2)
    ds_read_b64_tr_b16 v[136:137], v5 offset:8192
    ds_read_b64_tr_b16 v[138:139], v5 offset:8448
    ds_read_b64_tr_b16 v[140:141], v5 offset:8704
    ds_read_b64_tr_b16 v[142:143], v5 offset:8960
    s_waitcnt lgkmcnt(4)
    v_mfma_f32_32x32x16_bf16 v[104:119], v[96:99], v[84:87], v[104:119]
    v_mfma_f32_32x32x16_bf16 v[120:135], v[100:103], v[84:87], v[120:135]
    s_waitcnt vmcnt(0)
    ds_read_b64_tr_b16 v[144:145], v5 offset:10240
    ds_read_b64_tr_b16 v[146:147], v5 offset:10496
    ds_read_b64_tr_b16 v[148:149], v5 offset:10752
    ds_read_b64_tr_b16 v[150:151], v5 offset:11008
    s_waitcnt lgkmcnt(4)
    v_mfma_f32_32x32x16_bf16 v[104:119], v[136:139], v[88:91], v[104:119]
    v_mfma_f32_32x32x16_bf16 v[120:135], v[140:143], v[88:91], v[120:135]
    s_waitcnt lgkmcnt(0)
    v_mfma_f32_32x32x16_bf16 v[104:119], v[144:147], v[92:95], v[104:119]
    v_mfma_f32_32x32x16_bf16 v[120:135], v[148:151], v[92:95], v[120:135]
    s_nop 10
    ds_write_b128 v24, v[104:107] offset:0
    ds_write_b128 v24, v[108:111] offset:1024
    ds_write_b128 v24, v[112:115] offset:2048
    ds_write_b128 v24, v[116:119] offset:3072
    ds_write_b128 v24, v[120:123] offset:4096
    ds_write_b128 v24, v[124:127] offset:5120
    ds_write_b128 v24, v[128:131] offset:6144
    ds_write_b128 v24, v[132:135] offset:7168
    v_lshlrev_b32 v144, 16, v26
    v_and_b32 v145, 0xffff0000, v26
    v_lshlrev_b32 v146, 16, v27
    v_and_b32 v147, 0xffff0000, v27
    s_waitcnt lgkmcnt(0)
    s_barrier
    ds_read_b128 v[40:43], v25 offset:0
    ds_read_b128 v[44:47], v25 offset:12288
    ds_read_b128 v[48:51], v25 offset:24576
    ds_read_b128 v[52:55], v25 offset:36864
    ds_read_b128 v[56:59], v4 offset:0
    ds_read_b128 v[60:63], v4 offset:12288
    ds_read_b128 v[64:67], v4 offset:24576
    ds_read_b128 v[68:71], v4 offset:36864
    s_waitcnt lgkmcnt(6)
    v_add_f32 v40, v40, v44
    v_add_f32 v41, v41, v45
    v_add_f32 v42, v42, v46
    v_add_f32 v43, v43, v47
    v_add_f32 v144, v144, v40
    v_add_f32 v145, v145, v41
    v_add_f32 v146, v146, v42
    v_add_f32 v147, v147, v43
    s_waitcnt lgkmcnt(4)
    v_add_f32 v48, v48, v52
    v_add_f32 v49, v49, v53
    v_add_f32 v50, v50, v54
    v_add_f32 v51, v51, v55
    v_add_f32 v144, v144, v48
    v_add_f32 v145, v145, v49
    v_add_f32 v146, v146, v50
    v_add_f32 v147, v147, v51
    s_waitcnt lgkmcnt(2)
    v_add_f32 v56, v56, v60
    v_add_f32 v57, v57, v61
    v_add_f32 v58, v58, v62
    v_add_f32 v59, v59, v63
    v_add_f32 v144, v144, v56
    v_add_f32 v145, v145, v57
    v_add_f32 v146, v146, v58
    v_add_f32 v147, v147, v59
    s_waitcnt lgkmcnt(0)
    v_add_f32 v64, v64, v68
    v_add_f32 v65, v65, v69
    v_add_f32 v66, v66, v70
    v_add_f32 v67, v67, v71
    v_add_f32 v144, v144, v64
    v_add_f32 v145, v145, v65
    v_add_f32 v146, v146, v66
    v_add_f32 v147, v147, v67
    v_cvt_pk_bf16_f32 v144, v144, v145
    v_cvt_pk_bf16_f32 v145, v146, v147
    buffer_store_dwordx2 v[144:145], v22, s[40:43], s71 offen
    s_endpgm
L_CLASSL:
    v_bfe_u32 v12, v0, 3, 1
    v_bfe_u32 v13, v0, 4, 1
    v_bfe_u32 v14, v0, 5, 1
    v_lshlrev_b32 v12, 1, v12
    v_or_b32 v12, v12, v13
    v_lshl_add_u32 v12, v14, 2, v12
    v_lshlrev_b32 v12, 12, v12
    v_and_b32 v13, 1, v0
    v_lshl_add_u32 v12, v13, 4, v12
    v_bfe_u32 v13, v0, 1, 2
    v_xor_b32 v14, 0, v13
    v_lshl_add_u32 v1, v14, 5, v12
    v_xor_b32 v14, 1, v13
    v_lshl_add_u32 v2, v14, 5, v12
    v_xor_b32 v14, 2, v13
    v_lshl_add_u32 v3, v14, 5, v12
    v_xor_b32 v14, 3, v13
    v_lshl_add_u32 v4, v14, 5, v12
    s_waitcnt lgkmcnt(0)
    s_lshr_b32 s73, s60, 1
    s_lshl_b32 s73, s73, 10
    s_add_u32 s73, s73, 10485760
    s_add_u32 s56, s18, s73
    s_addc_u32 s57, s19, 0
    s_and_b32 s57, s57, 0xffff
    s_mov_b32 s58, 1024
    s_mov_b32 s59, 0x20000
    buffer_load_dword v18, off, s[56:59], 0 offset:384 sc1
    s_mov_b32 s24, s6
    s_and_b32 s25, s7, 0xffff
    s_mov_b32 s26, 524288
    s_mov_b32 s27, 0x20000
    s_mov_b32 s28, s8
    s_and_b32 s29, s9, 0xffff
    s_mov_b32 s30, 524288
    s_mov_b32 s31, 0x20000
    s_setprio 3
    s_barrier
    s_lshr_b32 s72, s2, 3
    s_mul_i32 s72, s72, 16384
    s_add_u32 s72, s72, 384
    v_lshlrev_b32 v20, 10, v0
    v_cmp_gt_u32 vcc, 16, v0
    v_mov_b32 v19, 0x40000000
    s_nop 0
    v_cndmask_b32 v20, v19, v20, vcc
    buffer_load_dword v21, v20, s[24:27], s72 offen
    s_lshr_b32 s72, s2, 3
    s_mul_i32 s72, s72, 16384
    s_add_u32 s72, s72, 384
    v_lshlrev_b32 v20, 10, v0
    v_cmp_gt_u32 vcc, 16, v0
    v_mov_b32 v19, 0x40000000
    s_nop 0
    v_cndmask_b32 v20, v19, v20, vcc
    buffer_load_dword v21, v20, s[28:31], s72 offen
    s_lshl_b32 s68, s101, 13
    s_add_u32 m0, s68, 32768
    s_lshl3_add_u32 s75, s68, s71
    buffer_load_dwordx4 v1, s[24:27], s75 offen offset:0 lds
    buffer_load_dwordx4 v2, s[24:27], s75 offen offset:1024 lds
    buffer_load_dwordx4 v3, s[24:27], s75 offen offset:2048 lds
    buffer_load_dwordx4 v4, s[24:27], s75 offen offset:3072 lds
    s_add_u32 s68, s68, 4096
    s_and_b32 s68, s68, 0xffff
    s_add_u32 m0, s68, 32768
    s_lshl3_add_u32 s75, s68, s71
    buffer_load_dwordx4 v1, s[24:27], s75 offen offset:0 lds
    buffer_load_dwordx4 v2, s[24:27], s75 offen offset:1024 lds
    buffer_load_dwordx4 v3, s[24:27], s75 offen offset:2048 lds
    buffer_load_dwordx4 v4, s[24:27], s75 offen offset:3072 lds
    s_add_u32 s68, s68, 4096
    s_and_b32 s68, s68, 0xffff
    s_add_u32 m0, s68, 32768
    s_lshl3_add_u32 s75, s68, s71
    buffer_load_dwordx4 v1, s[24:27], s75 offen offset:0 lds
    buffer_load_dwordx4 v2, s[24:27], s75 offen offset:1024 lds
    buffer_load_dwordx4 v3, s[24:27], s75 offen offset:2048 lds
    buffer_load_dwordx4 v4, s[24:27], s75 offen offset:3072 lds
    s_add_u32 s68, s68, 4096
    s_and_b32 s68, s68, 0xffff
    s_add_u32 m0, s68, 32768
    s_lshl3_add_u32 s75, s68, s71
    buffer_load_dwordx4 v1, s[24:27], s75 offen offset:0 lds
    buffer_load_dwordx4 v2, s[24:27], s75 offen offset:1024 lds
    buffer_load_dwordx4 v3, s[24:27], s75 offen offset:2048 lds
    buffer_load_dwordx4 v4, s[24:27], s75 offen offset:3072 lds
    s_lshl_b32 s72, s60, 15
    s_add_u32 s44, s18, s72
    s_addc_u32 s45, s19, 0
    s_and_b32 s45, s45, 0xffff
    s_mov_b32 s46, 32768
    s_mov_b32 s47, 0x20000
    s_add_u32 s73, s72, 1048576
    s_add_u32 s48, s18, s73
    s_addc_u32 s49, s19, 0
    s_and_b32 s49, s49, 0xffff
    s_mov_b32 s50, 32768
    s_mov_b32 s51, 0x20000
    v_and_b32 v16, 31, v0
    v_lshrrev_b32 v17, 5, v0
    v_lshlrev_b32 v10, 7, v16
    v_lshl_add_u32 v10, v17, 15, v10
    v_and_b32 v20, 0xfff, v10
    buffer_load_dword v21, v20, s[44:47], s79 offen
    buffer_load_dword v21, v20, s[48:51], s79 offen
    v_and_b32 v20, 0x180, v10
    buffer_load_dword v21, v20, s[56:59], 0 offen nt
    buffer_load_dword v21, off, s[56:59], 0 offset:640 nt
    s_waitcnt vmcnt(22)
    v_readfirstlane_b32 s65, v18
    s_nop 1
    s_mul_i32 s65, s65, 0x01000193
    s_add_u32 s65, s65, 0x9E3779B9
    s_getreg_b32 s74, hwreg(HW_REG_XCC_ID, 0, 4)
    s_add_u32 s74, s74, s65
    s_add_u32 s74, s74, 0x1000
    s_mov_b64 exec, 1
    s_lshl_b32 s73, s100, 2
    v_mov_b32 v19, s74
    buffer_store_dword v19, off, s[56:59], s73 offset:512 sc1
    s_mov_b64 exec, -1
    s_add_u32 s68, s68, 4096
    s_and_b32 s68, s68, 0xffff
    s_add_u32 m0, s68, 32768
    s_lshl3_add_u32 s75, s68, s71
    buffer_load_dwordx4 v1, s[24:27], s75 offen offset:0 lds
    buffer_load_dwordx4 v2, s[24:27], s75 offen offset:1024 lds
    buffer_load_dwordx4 v3, s[24:27], s75 offen offset:2048 lds
    buffer_load_dwordx4 v4, s[24:27], s75 offen offset:3072 lds
    s_add_u32 s68, s68, 4096
    s_and_b32 s68, s68, 0xffff
    s_add_u32 m0, s68, 32768
    s_lshl3_add_u32 s75, s68, s71
    buffer_load_dwordx4 v1, s[24:27], s75 offen offset:0 lds
    buffer_load_dwordx4 v2, s[24:27], s75 offen offset:1024 lds
    buffer_load_dwordx4 v3, s[24:27], s75 offen offset:2048 lds
    buffer_load_dwordx4 v4, s[24:27], s75 offen offset:3072 lds
    s_add_u32 s68, s68, 4096
    s_and_b32 s68, s68, 0xffff
    s_add_u32 m0, s68, 32768
    s_lshl3_add_u32 s75, s68, s71
    buffer_load_dwordx4 v1, s[24:27], s75 offen offset:0 lds
    buffer_load_dwordx4 v2, s[24:27], s75 offen offset:1024 lds
    buffer_load_dwordx4 v3, s[24:27], s75 offen offset:2048 lds
    buffer_load_dwordx4 v4, s[24:27], s75 offen offset:3072 lds
    s_add_u32 s68, s68, 4096
    s_and_b32 s68, s68, 0xffff
    s_add_u32 m0, s68, 32768
    s_lshl3_add_u32 s75, s68, s71
    buffer_load_dwordx4 v1, s[24:27], s75 offen offset:0 lds
    buffer_load_dwordx4 v2, s[24:27], s75 offen offset:1024 lds
    buffer_load_dwordx4 v3, s[24:27], s75 offen offset:2048 lds
    buffer_load_dwordx4 v4, s[24:27], s75 offen offset:3072 lds
    s_add_u32 s68, s68, 4096
    s_and_b32 s68, s68, 0xffff
    s_add_u32 m0, s68, 32768
    s_lshl3_add_u32 s75, s68, s71
    buffer_load_dwordx4 v1, s[24:27], s75 offen offset:0 lds
    buffer_load_dwordx4 v2, s[24:27], s75 offen offset:1024 lds
    buffer_load_dwordx4 v3, s[24:27], s75 offen offset:2048 lds
    buffer_load_dwordx4 v4, s[24:27], s75 offen offset:3072 lds
    s_add_u32 s68, s68, 4096
    s_and_b32 s68, s68, 0xffff
    s_add_u32 m0, s68, 32768
    s_lshl3_add_u32 s75, s68, s71
    buffer_load_dwordx4 v1, s[24:27], s75 offen offset:0 lds
    buffer_load_dwordx4 v2, s[24:27], s75 offen offset:1024 lds
    buffer_load_dwordx4 v3, s[24:27], s75 offen offset:2048 lds
    buffer_load_dwordx4 v4, s[24:27], s75 offen offset:3072 lds
    s_add_u32 s68, s68, 4096
    s_and_b32 s68, s68, 0xffff
    s_add_u32 m0, s68, 32768
    s_lshl3_add_u32 s75, s68, s71
    buffer_load_dwordx4 v1, s[24:27], s75 offen offset:0 lds
    buffer_load_dwordx4 v2, s[24:27], s75 offen offset:1024 lds
    buffer_load_dwordx4 v3, s[24:27], s75 offen offset:2048 lds
    buffer_load_dwordx4 v4, s[24:27], s75 offen offset:3072 lds
    s_add_u32 s68, s68, 4096
    s_and_b32 s68, s68, 0xffff
    s_add_u32 m0, s68, 32768
    s_lshl3_add_u32 s75, s68, s71
    buffer_load_dwordx4 v1, s[24:27], s75 offen offset:0 lds
    buffer_load_dwordx4 v2, s[24:27], s75 offen offset:1024 lds
    buffer_load_dwordx4 v3, s[24:27], s75 offen offset:2048 lds
    buffer_load_dwordx4 v4, s[24:27], s75 offen offset:3072 lds
    s_add_u32 s68, s68, 4096
    s_and_b32 s68, s68, 0xffff
    s_add_u32 m0, s68, 32768
    s_lshl3_add_u32 s75, s68, s71
    buffer_load_dwordx4 v1, s[24:27], s75 offen offset:0 lds
    buffer_load_dwordx4 v2, s[24:27], s75 offen offset:1024 lds
    buffer_load_dwordx4 v3, s[24:27], s75 offen offset:2048 lds
    buffer_load_dwordx4 v4, s[24:27], s75 offen offset:3072 lds
    s_add_u32 s68, s68, 4096
    s_and_b32 s68, s68, 0xffff
    s_add_u32 m0, s68, 32768
    s_lshl3_add_u32 s75, s68, s71
    buffer_load_dwordx4 v1, s[24:27], s75 offen offset:0 lds
    buffer_load_dwordx4 v2, s[24:27], s75 offen offset:1024 lds
    buffer_load_dwordx4 v3, s[24:27], s75 offen offset:2048 lds
    buffer_load_dwordx4 v4, s[24:27], s75 offen offset:3072 lds
    s_add_u32 s68, s68, 4096
    s_and_b32 s68, s68, 0xffff
    s_add_u32 m0, s68, 32768
    s_lshl3_add_u32 s75, s68, s71
    buffer_load_dwordx4 v1, s[24:27], s75 offen offset:0 lds
    buffer_load_dwordx4 v2, s[24:27], s75 offen offset:1024 lds
    buffer_load_dwordx4 v3, s[24:27], s75 offen offset:2048 lds
    buffer_load_dwordx4 v4, s[24:27], s75 offen offset:3072 lds
    s_add_u32 s68, s68, 4096
    s_and_b32 s68, s68, 0xffff
    s_add_u32 m0, s68, 32768
    s_lshl3_add_u32 s75, s68, s71
    buffer_load_dwordx4 v1, s[24:27], s75 offen offset:0 lds
    buffer_load_dwordx4 v2, s[24:27], s75 offen offset:1024 lds
    buffer_load_dwordx4 v3, s[24:27], s75 offen offset:2048 lds
    buffer_load_dwordx4 v4, s[24:27], s75 offen offset:3072 lds
    s_barrier
    s_and_b32 s73, s100, 8
    v_and_b32 v13, 7, v0
    v_add_u32 v13, s73, v13
    v_lshlrev_b32 v13, 2, v13
    v_and_b32 v11, 15, v0
    v_lshlrev_b32 v11, 2, v11
    buffer_load_dword v15, v11, s[56:59], 0 offen offset:512 sc1
    s_lshl_b32 s68, s101, 13
    s_add_u32 m0, s68, 98304
    s_lshl3_add_u32 s75, s68, s71
    buffer_load_dwordx4 v1, s[28:31], s75 offen offset:0 lds
    buffer_load_dwordx4 v2, s[28:31], s75 offen offset:1024 lds
    buffer_load_dwordx4 v3, s[28:31], s75 offen offset:2048 lds
    buffer_load_dwordx4 v4, s[28:31], s75 offen offset:3072 lds
    s_add_u32 s68, s68, 4096
    s_and_b32 s68, s68, 0xffff
    s_add_u32 m0, s68, 98304
    s_lshl3_add_u32 s75, s68, s71
    buffer_load_dwordx4 v1, s[28:31], s75 offen offset:0 lds
    buffer_load_dwordx4 v2, s[28:31], s75 offen offset:1024 lds
    buffer_load_dwordx4 v3, s[28:31], s75 offen offset:2048 lds
    buffer_load_dwordx4 v4, s[28:31], s75 offen offset:3072 lds
    s_add_u32 s68, s68, 4096
    s_and_b32 s68, s68, 0xffff
    s_add_u32 m0, s68, 98304
    s_lshl3_add_u32 s75, s68, s71
    buffer_load_dwordx4 v1, s[28:31], s75 offen offset:0 lds
    buffer_load_dwordx4 v2, s[28:31], s75 offen offset:1024 lds
    buffer_load_dwordx4 v3, s[28:31], s75 offen offset:2048 lds
    buffer_load_dwordx4 v4, s[28:31], s75 offen offset:3072 lds
    s_add_u32 s68, s68, 4096
    s_and_b32 s68, s68, 0xffff
    s_add_u32 m0, s68, 98304
    s_lshl3_add_u32 s75, s68, s71
    buffer_load_dwordx4 v1, s[28:31], s75 offen offset:0 lds
    buffer_load_dwordx4 v2, s[28:31], s75 offen offset:1024 lds
    buffer_load_dwordx4 v3, s[28:31], s75 offen offset:2048 lds
    buffer_load_dwordx4 v4, s[28:31], s75 offen offset:3072 lds
    s_mov_b32 s32, s10
    s_and_b32 s33, s11, 0xffff
    s_mov_b32 s34, 1835008
    s_mov_b32 s35, 0x20000
    s_mov_b32 s36, s12
    s_and_b32 s37, s13, 0xffff
    s_mov_b32 s38, 1835008
    s_mov_b32 s39, 0x20000
    s_mul_i32 s69, s61, 448
    s_lshr_b32 s74, s101, 1
    s_add_u32 s73, s74, 0
    s_and_b32 s73, s73, 3
    s_mul_i32 s73, s73, 458752
    s_add_u32 s66, s73, s69
    s_add_u32 s73, s74, 1
    s_and_b32 s73, s73, 3
    s_mul_i32 s73, s73, 458752
    s_add_u32 s67, s73, s69
    v_lshrrev_b32 v16, 2, v0
    v_and_b32 v17, 3, v0
    v_lshlrev_b32 v17, 4, v17
    s_movk_i32 s72, 3584
    v_mad_u32_u24 v5, v16, s72, v17
    v_and_b32 v16, 31, v0
    v_lshrrev_b32 v17, 5, v0
    v_mov_b32 v20, 0x40000000
    v_add_u32 v19, -1, v16
    v_cmp_gt_u32 vcc, 32, v19
    v_lshlrev_b32 v19, 4, v19
    v_lshl_add_u32 v19, v17, 9, v19
    v_cndmask_b32 v6, v20, v19, vcc
    v_add_u32 v19, 1, v16
    v_cmp_gt_u32 vcc, 32, v19
    v_lshlrev_b32 v19, 4, v19
    v_lshl_add_u32 v19, v17, 9, v19
    v_cndmask_b32 v7, v20, v19, vcc
    v_add_u32 v19, -2, v16
    v_cmp_gt_u32 vcc, 32, v19
    v_lshlrev_b32 v19, 4, v19
    v_lshl_add_u32 v19, v17, 9, v19
    v_cndmask_b32 v8, v20, v19, vcc
    v_add_u32 v19, 2, v16
    v_cmp_gt_u32 vcc, 32, v19
    v_lshlrev_b32 v19, 4, v19
    v_lshl_add_u32 v19, v17, 9, v19
    v_cndmask_b32 v9, v20, v19, vcc
    s_add_u32 s68, s68, 4096
    s_and_b32 s68, s68, 0xffff
    s_add_u32 m0, s68, 98304
    s_lshl3_add_u32 s75, s68, s71
    buffer_load_dwordx4 v1, s[28:31], s75 offen offset:0 lds
    buffer_load_dwordx4 v2, s[28:31], s75 offen offset:1024 lds
    buffer_load_dwordx4 v3, s[28:31], s75 offen offset:2048 lds
    buffer_load_dwordx4 v4, s[28:31], s75 offen offset:3072 lds
    s_add_u32 s68, s68, 4096
    s_and_b32 s68, s68, 0xffff
    s_add_u32 m0, s68, 98304
    s_lshl3_add_u32 s75, s68, s71
    buffer_load_dwordx4 v1, s[28:31], s75 offen offset:0 lds
    buffer_load_dwordx4 v2, s[28:31], s75 offen offset:1024 lds
    buffer_load_dwordx4 v3, s[28:31], s75 offen offset:2048 lds
    buffer_load_dwordx4 v4, s[28:31], s75 offen offset:3072 lds
    s_add_u32 s68, s68, 4096
    s_and_b32 s68, s68, 0xffff
    s_add_u32 m0, s68, 98304
    s_lshl3_add_u32 s75, s68, s71
    buffer_load_dwordx4 v1, s[28:31], s75 offen offset:0 lds
    buffer_load_dwordx4 v2, s[28:31], s75 offen offset:1024 lds
    buffer_load_dwordx4 v3, s[28:31], s75 offen offset:2048 lds
    buffer_load_dwordx4 v4, s[28:31], s75 offen offset:3072 lds
    s_add_u32 s68, s68, 4096
    s_and_b32 s68, s68, 0xffff
    s_add_u32 m0, s68, 98304
    s_lshl3_add_u32 s75, s68, s71
    buffer_load_dwordx4 v1, s[28:31], s75 offen offset:0 lds
    buffer_load_dwordx4 v2, s[28:31], s75 offen offset:1024 lds
    buffer_load_dwordx4 v3, s[28:31], s75 offen offset:2048 lds
    buffer_load_dwordx4 v4, s[28:31], s75 offen offset:3072 lds
    s_waitcnt vmcnt(33)
    s_barrier
    s_and_b32 s73, s2, 7
    s_movk_i32 s74, 15
    s_lshr_b32 s74, s74, s73
    s_and_b32 s74, s74, 1
    s_cmp_eq_u32 s74, 0
    s_cbranch_scc1 L_NOWARM6
    s_lshr_b32 s72, s2, 3
    s_mul_i32 s72, s72, 4
    s_add_u32 s72, s72, s73
    s_mul_i32 s72, s72, 14336
    v_lshlrev_b32 v20, 7, v0
    buffer_load_dword v21, v20, s[32:35], s72 offen
    s_add_u32 s73, s72, 8192
    buffer_load_dword v21, v20, s[32:35], s73 offen
    buffer_load_dword v21, v20, s[36:39], s72 offen
    s_add_u32 s73, s72, 8192
    buffer_load_dword v21, v20, s[36:39], s73 offen
L_NOWARM6:
    s_add_u32 s68, s68, 4096
    s_and_b32 s68, s68, 0xffff
    s_add_u32 m0, s68, 98304
    s_lshl3_add_u32 s75, s68, s71
    buffer_load_dwordx4 v1, s[28:31], s75 offen offset:0 lds
    buffer_load_dwordx4 v2, s[28:31], s75 offen offset:1024 lds
    buffer_load_dwordx4 v3, s[28:31], s75 offen offset:2048 lds
    buffer_load_dwordx4 v4, s[28:31], s75 offen offset:3072 lds
    s_add_u32 s68, s68, 4096
    s_and_b32 s68, s68, 0xffff
    s_add_u32 m0, s68, 98304
    s_lshl3_add_u32 s75, s68, s71
    buffer_load_dwordx4 v1, s[28:31], s75 offen offset:0 lds
    buffer_load_dwordx4 v2, s[28:31], s75 offen offset:1024 lds
    buffer_load_dwordx4 v3, s[28:31], s75 offen offset:2048 lds
    buffer_load_dwordx4 v4, s[28:31], s75 offen offset:3072 lds
    s_add_u32 s68, s68, 4096
    s_and_b32 s68, s68, 0xffff
    s_add_u32 m0, s68, 98304
    s_lshl3_add_u32 s75, s68, s71
    buffer_load_dwordx4 v1, s[28:31], s75 offen offset:0 lds
    buffer_load_dwordx4 v2, s[28:31], s75 offen offset:1024 lds
    buffer_load_dwordx4 v3, s[28:31], s75 offen offset:2048 lds
    buffer_load_dwordx4 v4, s[28:31], s75 offen offset:3072 lds
    s_add_u32 s68, s68, 4096
    s_and_b32 s68, s68, 0xffff
    s_add_u32 m0, s68, 98304
    s_lshl3_add_u32 s75, s68, s71
    buffer_load_dwordx4 v1, s[28:31], s75 offen offset:0 lds
    buffer_load_dwordx4 v2, s[28:31], s75 offen offset:1024 lds
    buffer_load_dwordx4 v3, s[28:31], s75 offen offset:2048 lds
    buffer_load_dwordx4 v4, s[28:31], s75 offen offset:3072 lds
    s_waitcnt vmcnt(48)
    s_getreg_b32 s74, hwreg(HW_REG_XCC_ID, 0, 4)
    s_add_u32 s74, s74, s65
    s_add_u32 s74, s74, 0x1000
    v_cmp_ne_u32 vcc, s74, v15
    s_nop 1
    s_cmp_eq_u64 vcc, 0
    s_cselect_b32 s63, 1, 0
    v_mov_b32 v16, s63
    v_mov_b32 v17, 0
    ds_write_b32 v17, v16
    s_waitcnt lgkmcnt(0)
    s_barrier
    s_add_u32 s68, s68, 4096
    s_and_b32 s68, s68, 0xffff
    s_add_u32 m0, s68, 98304
    s_lshl3_add_u32 s75, s68, s71
    buffer_load_dwordx4 v1, s[28:31], s75 offen offset:0 lds
    buffer_load_dwordx4 v2, s[28:31], s75 offen offset:1024 lds
    buffer_load_dwordx4 v3, s[28:31], s75 offen offset:2048 lds
    buffer_load_dwordx4 v4, s[28:31], s75 offen offset:3072 lds
    s_add_u32 s68, s68, 4096
    s_and_b32 s68, s68, 0xffff
    s_add_u32 m0, s68, 98304
    s_lshl3_add_u32 s75, s68, s71
    buffer_load_dwordx4 v1, s[28:31], s75 offen offset:0 lds
    buffer_load_dwordx4 v2, s[28:31], s75 offen offset:1024 lds
    buffer_load_dwordx4 v3, s[28:31], s75 offen offset:2048 lds
    buffer_load_dwordx4 v4, s[28:31], s75 offen offset:3072 lds
    s_add_u32 s68, s68, 4096
    s_and_b32 s68, s68, 0xffff
    s_add_u32 m0, s68, 98304
    s_lshl3_add_u32 s75, s68, s71
    buffer_load_dwordx4 v1, s[28:31], s75 offen offset:0 lds
    buffer_load_dwordx4 v2, s[28:31], s75 offen offset:1024 lds
    buffer_load_dwordx4 v3, s[28:31], s75 offen offset:2048 lds
    buffer_load_dwordx4 v4, s[28:31], s75 offen offset:3072 lds
    s_add_u32 s68, s68, 4096
    s_and_b32 s68, s68, 0xffff
    s_add_u32 m0, s68, 98304
    s_lshl3_add_u32 s75, s68, s71
    buffer_load_dwordx4 v1, s[28:31], s75 offen offset:0 lds
    buffer_load_dwordx4 v2, s[28:31], s75 offen offset:1024 lds
    buffer_load_dwordx4 v3, s[28:31], s75 offen offset:2048 lds
    buffer_load_dwordx4 v4, s[28:31], s75 offen offset:3072 lds
    s_waitcnt vmcnt(0)
    s_barrier
    s_mov_b64 exec, 1
    s_lshl_b32 s72, s100, 2
    v_mov_b32 v12, s65
    s_cmp_eq_u32 s63, 0
    s_cbranch_scc1 L_SLOW7
    buffer_store_dword v12, off, s[56:59], s72 offset:0
    s_branch L_DONE7
L_SLOW7:
    buffer_store_dword v12, off, s[56:59], s72 offset:0 sc1
L_DONE7:
    s_mov_b64 exec, -1
    s_mov_b32 s3, 200000
L_POLL0:
    s_cmp_eq_u32 s63, 0
    s_cbranch_scc1 L_SLOW8
    buffer_load_dword v14, v13, s[56:59], 0 offen offset:0 nt
    s_branch L_DONE8
L_SLOW8:
    buffer_load_dword v14, v13, s[56:59], 0 offen offset:0 sc1
L_DONE8:
    s_waitcnt vmcnt(0)
    v_cmp_ne_u32 vcc, s65, v14
    s_sub_u32 s3, s3, 1
    s_cbranch_scc1 L_POLLX0
    s_cmp_lg_u64 vcc, 0
    s_cbranch_scc1 L_POLL0
L_POLLX0:
    s_cmp_eq_u32 s63, 1
    s_cbranch_scc1 L_LMODEOK
    buffer_load_dword v15, v11, s[56:59], 0 offen offset:512 sc1
    s_waitcnt vmcnt(0)
    s_getreg_b32 s74, hwreg(HW_REG_XCC_ID, 0, 4)
    s_add_u32 s74, s74, s65
    s_add_u32 s74, s74, 0x1000
    v_cmp_ne_u32 vcc, s74, v15
    s_nop 1
    s_cmp_eq_u64 vcc, 0
    s_cselect_b32 s63, 1, 0
L_LMODEOK:
    v_mov_b32 v16, s63
    v_mov_b32 v17, 32832
    ds_write_b32 v17, v16
    s_cmp_eq_u32 s63, 0
    s_cbranch_scc1 L_SLOW9
    s_mov_b32 m0, 0
    s_mov_b32 s75, 0
    buffer_load_dwordx4 v6, s[44:47], s75 offen offset:0 nt lds
    buffer_load_dwordx4 v6, s[44:47], s75 offen offset:1024 nt lds
    buffer_load_dwordx4 v6, s[44:47], s75 offen offset:2048 nt lds
    buffer_load_dwordx4 v6, s[44:47], s75 offen offset:3072 nt lds
    s_mov_b32 m0, 4096
    s_mov_b32 s75, 4096
    buffer_load_dwordx4 v6, s[44:47], s75 offen offset:0 nt lds
    buffer_load_dwordx4 v6, s[44:47], s75 offen offset:1024 nt lds
    buffer_load_dwordx4 v6, s[44:47], s75 offen offset:2048 nt lds
    buffer_load_dwordx4 v6, s[44:47], s75 offen offset:3072 nt lds
    s_mov_b32 m0, 8192
    s_mov_b32 s75, 8192
    buffer_load_dwordx4 v7, s[44:47], s75 offen offset:0 nt lds
    buffer_load_dwordx4 v7, s[44:47], s75 offen offset:1024 nt lds
    buffer_load_dwordx4 v7, s[44:47], s75 offen offset:2048 nt lds
    buffer_load_dwordx4 v7, s[44:47], s75 offen offset:3072 nt lds
    s_mov_b32 m0, 12288
    s_mov_b32 s75, 12288
    buffer_load_dwordx4 v7, s[44:47], s75 offen offset:0 nt lds
    buffer_load_dwordx4 v7, s[44:47], s75 offen offset:1024 nt lds
    buffer_load_dwordx4 v7, s[44:47], s75 offen offset:2048 nt lds
    buffer_load_dwordx4 v7, s[44:47], s75 offen offset:3072 nt lds
    s_mov_b32 m0, 16384
    s_mov_b32 s75, 16384
    buffer_load_dwordx4 v8, s[44:47], s75 offen offset:0 nt lds
    buffer_load_dwordx4 v8, s[44:47], s75 offen offset:1024 nt lds
    buffer_load_dwordx4 v8, s[44:47], s75 offen offset:2048 nt lds
    buffer_load_dwordx4 v8, s[44:47], s75 offen offset:3072 nt lds
    s_mov_b32 m0, 20480
    s_mov_b32 s75, 20480
    buffer_load_dwordx4 v8, s[44:47], s75 offen offset:0 nt lds
    buffer_load_dwordx4 v8, s[44:47], s75 offen offset:1024 nt lds
    buffer_load_dwordx4 v8, s[44:47], s75 offen offset:2048 nt lds
    buffer_load_dwordx4 v8, s[44:47], s75 offen offset:3072 nt lds
    s_mov_b32 m0, 24576
    s_mov_b32 s75, 24576
    buffer_load_dwordx4 v9, s[44:47], s75 offen offset:0 nt lds
    buffer_load_dwordx4 v9, s[44:47], s75 offen offset:1024 nt lds
    buffer_load_dwordx4 v9, s[44:47], s75 offen offset:2048 nt lds
    buffer_load_dwordx4 v9, s[44:47], s75 offen offset:3072 nt lds
    s_mov_b32 m0, 28672
    s_mov_b32 s75, 28672
    buffer_load_dwordx4 v9, s[44:47], s75 offen offset:0 nt lds
    buffer_load_dwordx4 v9, s[44:47], s75 offen offset:1024 nt lds
    buffer_load_dwordx4 v9, s[44:47], s75 offen offset:2048 nt lds
    buffer_load_dwordx4 v9, s[44:47], s75 offen offset:3072 nt lds
    s_branch L_DONE9
L_SLOW9:
    s_mov_b32 m0, 0
    s_mov_b32 s75, 0
    buffer_load_dwordx4 v6, s[44:47], s75 offen offset:0 sc1 lds
    buffer_load_dwordx4 v6, s[44:47], s75 offen offset:1024 sc1 lds
    buffer_load_dwordx4 v6, s[44:47], s75 offen offset:2048 sc1 lds
    buffer_load_dwordx4 v6, s[44:47], s75 offen offset:3072 sc1 lds
    s_mov_b32 m0, 4096
    s_mov_b32 s75, 4096
    buffer_load_dwordx4 v6, s[44:47], s75 offen offset:0 sc1 lds
    buffer_load_dwordx4 v6, s[44:47], s75 offen offset:1024 sc1 lds
    buffer_load_dwordx4 v6, s[44:47], s75 offen offset:2048 sc1 lds
    buffer_load_dwordx4 v6, s[44:47], s75 offen offset:3072 sc1 lds
    s_mov_b32 m0, 8192
    s_mov_b32 s75, 8192
    buffer_load_dwordx4 v7, s[44:47], s75 offen offset:0 sc1 lds
    buffer_load_dwordx4 v7, s[44:47], s75 offen offset:1024 sc1 lds
    buffer_load_dwordx4 v7, s[44:47], s75 offen offset:2048 sc1 lds
    buffer_load_dwordx4 v7, s[44:47], s75 offen offset:3072 sc1 lds
    s_mov_b32 m0, 12288
    s_mov_b32 s75, 12288
    buffer_load_dwordx4 v7, s[44:47], s75 offen offset:0 sc1 lds
    buffer_load_dwordx4 v7, s[44:47], s75 offen offset:1024 sc1 lds
    buffer_load_dwordx4 v7, s[44:47], s75 offen offset:2048 sc1 lds
    buffer_load_dwordx4 v7, s[44:47], s75 offen offset:3072 sc1 lds
    s_mov_b32 m0, 16384
    s_mov_b32 s75, 16384
    buffer_load_dwordx4 v8, s[44:47], s75 offen offset:0 sc1 lds
    buffer_load_dwordx4 v8, s[44:47], s75 offen offset:1024 sc1 lds
    buffer_load_dwordx4 v8, s[44:47], s75 offen offset:2048 sc1 lds
    buffer_load_dwordx4 v8, s[44:47], s75 offen offset:3072 sc1 lds
    s_mov_b32 m0, 20480
    s_mov_b32 s75, 20480
    buffer_load_dwordx4 v8, s[44:47], s75 offen offset:0 sc1 lds
    buffer_load_dwordx4 v8, s[44:47], s75 offen offset:1024 sc1 lds
    buffer_load_dwordx4 v8, s[44:47], s75 offen offset:2048 sc1 lds
    buffer_load_dwordx4 v8, s[44:47], s75 offen offset:3072 sc1 lds
    s_mov_b32 m0, 24576
    s_mov_b32 s75, 24576
    buffer_load_dwordx4 v9, s[44:47], s75 offen offset:0 sc1 lds
    buffer_load_dwordx4 v9, s[44:47], s75 offen offset:1024 sc1 lds
    buffer_load_dwordx4 v9, s[44:47], s75 offen offset:2048 sc1 lds
    buffer_load_dwordx4 v9, s[44:47], s75 offen offset:3072 sc1 lds
    s_mov_b32 m0, 28672
    s_mov_b32 s75, 28672
    buffer_load_dwordx4 v9, s[44:47], s75 offen offset:0 sc1 lds
    buffer_load_dwordx4 v9, s[44:47], s75 offen offset:1024 sc1 lds
    buffer_load_dwordx4 v9, s[44:47], s75 offen offset:2048 sc1 lds
    buffer_load_dwordx4 v9, s[44:47], s75 offen offset:3072 sc1 lds
L_DONE9:
    s_waitcnt vmcnt(0)
    s_waitcnt lgkmcnt(0)
    s_barrier
    s_cmp_ge_u32 s100, 14
    s_cbranch_scc1 L_NOPRE
    s_lshl_b32 s68, s100, 8
    s_mov_b32 m0, 65536
    s_add_u32 s75, s68, 0
    buffer_load_dwordx4 v5, s[32:35], s75 offen lds
    s_mov_b32 m0, 77824
    s_add_u32 s75, s68, 64
    buffer_load_dwordx4 v5, s[32:35], s75 offen lds
    s_mov_b32 m0, 90112
    s_add_u32 s75, s68, 128
    buffer_load_dwordx4 v5, s[32:35], s75 offen lds
    s_mov_b32 m0, 102400
    s_add_u32 s75, s68, 192
    buffer_load_dwordx4 v5, s[32:35], s75 offen lds
    s_mov_b32 m0, 114688
    s_add_u32 s75, s68, 917504
    buffer_load_dwordx4 v5, s[32:35], s75 offen lds
    s_mov_b32 m0, 126976
    s_add_u32 s75, s68, 917568
    buffer_load_dwordx4 v5, s[32:35], s75 offen lds
    s_mov_b32 m0, 139264
    s_add_u32 s75, s68, 917632
    buffer_load_dwordx4 v5, s[32:35], s75 offen lds
    s_mov_b32 m0, 151552
    s_add_u32 s75, s68, 917696
    buffer_load_dwordx4 v5, s[32:35], s75 offen lds
    s_mov_b32 m0, 66560
    s_add_u32 s75, s68, 57344
    buffer_load_dwordx4 v5, s[32:35], s75 offen lds
    s_mov_b32 m0, 78848
    s_add_u32 s75, s68, 57408
    buffer_load_dwordx4 v5, s[32:35], s75 offen lds
    s_mov_b32 m0, 91136
    s_add_u32 s75, s68, 57472
    buffer_load_dwordx4 v5, s[32:35], s75 offen lds
    s_mov_b32 m0, 103424
    s_add_u32 s75, s68, 57536
    buffer_load_dwordx4 v5, s[32:35], s75 offen lds
    s_mov_b32 m0, 115712
    s_add_u32 s75, s68, 974848
    buffer_load_dwordx4 v5, s[32:35], s75 offen lds
    s_mov_b32 m0, 128000
    s_add_u32 s75, s68, 974912
    buffer_load_dwordx4 v5, s[32:35], s75 offen lds
    s_mov_b32 m0, 140288
    s_add_u32 s75, s68, 974976
    buffer_load_dwordx4 v5, s[32:35], s75 offen lds
    s_mov_b32 m0, 152576
    s_add_u32 s75, s68, 975040
    buffer_load_dwordx4 v5, s[32:35], s75 offen lds
L_NOPRE:
    s_barrier
    s_mov_b64 exec, 1
    s_lshl_b32 s72, s100, 2
    v_mov_b32 v12, s65
    s_cmp_eq_u32 s63, 0
    s_cbranch_scc1 L_SLOW10
    buffer_store_dword v12, off, s[56:59], s72 offset:128
    s_branch L_DONE10
L_SLOW10:
    buffer_store_dword v12, off, s[56:59], s72 offset:128 sc1
L_DONE10:
    s_mov_b64 exec, -1
    s_mov_b32 s3, 200000
L_POLL1:
    s_cmp_eq_u32 s63, 0
    s_cbranch_scc1 L_SLOW11
    buffer_load_dword v14, v11, s[56:59], 0 offen offset:128 nt
    s_branch L_DONE11
L_SLOW11:
    buffer_load_dword v14, v11, s[56:59], 0 offen offset:128 sc1
L_DONE11:
    s_waitcnt vmcnt(0)
    v_cmp_ne_u32 vcc, s65, v14
    s_sub_u32 s3, s3, 1
    s_cbranch_scc1 L_POLLX1
    s_cmp_lg_u64 vcc, 0
    s_cbranch_scc1 L_POLL1
L_POLLX1:
    s_cmp_eq_u32 s63, 1
    s_cbranch_scc1 L_LMODEOK3
    buffer_load_dword v15, v11, s[56:59], 0 offen offset:512 sc1
    s_waitcnt vmcnt(0)
    s_getreg_b32 s74, hwreg(HW_REG_XCC_ID, 0, 4)
    s_add_u32 s74, s74, s65
    s_add_u32 s74, s74, 0x1000
    v_cmp_ne_u32 vcc, s74, v15
    s_nop 1
    s_cmp_eq_u64 vcc, 0
    s_cselect_b32 s63, 1, 0
L_LMODEOK3:
    v_mov_b32 v16, s63
    v_mov_b32 v17, 32896
    ds_write_b32 v17, v16
    s_waitcnt lgkmcnt(0)
    s_barrier
    s_barrier
    s_cmp_ge_u32 s100, 14
    s_cbranch_scc0 L_LACT
    s_mov_b64 exec, 1
    s_lshl_b32 s72, s100, 2
    v_mov_b32 v12, s65
    s_cmp_eq_u32 s63, 0
    s_cbranch_scc1 L_SLOW12
    buffer_store_dword v12, off, s[56:59], s72 offset:256
    s_branch L_DONE12
L_SLOW12:
    buffer_store_dword v12, off, s[56:59], s72 offset:256 sc1
L_DONE12:
    s_mov_b64 exec, -1
    s_branch L_LJOIN
L_LACT:
    s_lshl_b32 s68, s100, 8
    s_mov_b32 m0, 67584
    s_add_u32 s75, s68, 114688
    buffer_load_dwordx4 v5, s[32:35], s75 offen lds
    s_mov_b32 m0, 79872
    s_add_u32 s75, s68, 114752
    buffer_load_dwordx4 v5, s[32:35], s75 offen lds
    s_mov_b32 m0, 92160
    s_add_u32 s75, s68, 114816
    buffer_load_dwordx4 v5, s[32:35], s75 offen lds
    s_mov_b32 m0, 104448
    s_add_u32 s75, s68, 114880
    buffer_load_dwordx4 v5, s[32:35], s75 offen lds
    s_mov_b32 m0, 116736
    s_add_u32 s75, s68, 1032192
    buffer_load_dwordx4 v5, s[32:35], s75 offen lds
    s_mov_b32 m0, 129024
    s_add_u32 s75, s68, 1032256
    buffer_load_dwordx4 v5, s[32:35], s75 offen lds
    s_mov_b32 m0, 141312
    s_add_u32 s75, s68, 1032320
    buffer_load_dwordx4 v5, s[32:35], s75 offen lds
    s_mov_b32 m0, 153600
    s_add_u32 s75, s68, 1032384
    buffer_load_dwordx4 v5, s[32:35], s75 offen lds
    s_mov_b32 m0, 68608
    s_add_u32 s75, s68, 172032
    buffer_load_dwordx4 v5, s[32:35], s75 offen lds
    s_mov_b32 m0, 80896
    s_add_u32 s75, s68, 172096
    buffer_load_dwordx4 v5, s[32:35], s75 offen lds
    s_mov_b32 m0, 93184
    s_add_u32 s75, s68, 172160
    buffer_load_dwordx4 v5, s[32:35], s75 offen lds
    s_mov_b32 m0, 105472
    s_add_u32 s75, s68, 172224
    buffer_load_dwordx4 v5, s[32:35], s75 offen lds
    s_mov_b32 m0, 117760
    s_add_u32 s75, s68, 1089536
    buffer_load_dwordx4 v5, s[32:35], s75 offen lds
    s_mov_b32 m0, 130048
    s_add_u32 s75, s68, 1089600
    buffer_load_dwordx4 v5, s[32:35], s75 offen lds
    s_mov_b32 m0, 142336
    s_add_u32 s75, s68, 1089664
    buffer_load_dwordx4 v5, s[32:35], s75 offen lds
    s_mov_b32 m0, 154624
    s_add_u32 s75, s68, 1089728
    buffer_load_dwordx4 v5, s[32:35], s75 offen lds
    s_mov_b32 m0, 69632
    s_add_u32 s75, s68, 229376
    buffer_load_dwordx4 v5, s[32:35], s75 offen lds
    s_mov_b32 m0, 81920
    s_add_u32 s75, s68, 229440
    buffer_load_dwordx4 v5, s[32:35], s75 offen lds
    s_mov_b32 m0, 94208
    s_add_u32 s75, s68, 229504
    buffer_load_dwordx4 v5, s[32:35], s75 offen lds
    s_mov_b32 m0, 106496
    s_add_u32 s75, s68, 229568
    buffer_load_dwordx4 v5, s[32:35], s75 offen lds
    s_mov_b32 m0, 118784
    s_add_u32 s75, s68, 1146880
    buffer_load_dwordx4 v5, s[32:35], s75 offen lds
    s_mov_b32 m0, 131072
    s_add_u32 s75, s68, 1146944
    buffer_load_dwordx4 v5, s[32:35], s75 offen lds
    s_mov_b32 m0, 143360
    s_add_u32 s75, s68, 1147008
    buffer_load_dwordx4 v5, s[32:35], s75 offen lds
    s_mov_b32 m0, 155648
    s_add_u32 s75, s68, 1147072
    buffer_load_dwordx4 v5, s[32:35], s75 offen lds
    s_mov_b32 m0, 70656
    s_add_u32 s75, s68, 286720
    buffer_load_dwordx4 v5, s[32:35], s75 offen lds
    s_mov_b32 m0, 82944
    s_add_u32 s75, s68, 286784
    buffer_load_dwordx4 v5, s[32:35], s75 offen lds
    s_mov_b32 m0, 95232
    s_add_u32 s75, s68, 286848
    buffer_load_dwordx4 v5, s[32:35], s75 offen lds
    s_mov_b32 m0, 107520
    s_add_u32 s75, s68, 286912
    buffer_load_dwordx4 v5, s[32:35], s75 offen lds
    s_mov_b32 m0, 119808
    s_add_u32 s75, s68, 1204224
    buffer_load_dwordx4 v5, s[32:35], s75 offen lds
    s_mov_b32 m0, 132096
    s_add_u32 s75, s68, 1204288
    buffer_load_dwordx4 v5, s[32:35], s75 offen lds
    s_mov_b32 m0, 144384
    s_add_u32 s75, s68, 1204352
    buffer_load_dwordx4 v5, s[32:35], s75 offen lds
    s_mov_b32 m0, 156672
    s_add_u32 s75, s68, 1204416
    buffer_load_dwordx4 v5, s[32:35], s75 offen lds
    s_mov_b32 m0, 71680
    s_add_u32 s75, s68, 344064
    buffer_load_dwordx4 v5, s[32:35], s75 offen lds
    s_mov_b32 m0, 83968
    s_add_u32 s75, s68, 344128
    buffer_load_dwordx4 v5, s[32:35], s75 offen lds
    s_mov_b32 m0, 96256
    s_add_u32 s75, s68, 344192
    buffer_load_dwordx4 v5, s[32:35], s75 offen lds
    s_mov_b32 m0, 108544
    s_add_u32 s75, s68, 344256
    buffer_load_dwordx4 v5, s[32:35], s75 offen lds
    s_mov_b32 m0, 120832
    s_add_u32 s75, s68, 1261568
    buffer_load_dwordx4 v5, s[32:35], s75 offen lds
    s_mov_b32 m0, 133120
    s_add_u32 s75, s68, 1261632
    buffer_load_dwordx4 v5, s[32:35], s75 offen lds
    s_mov_b32 m0, 145408
    s_add_u32 s75, s68, 1261696
    buffer_load_dwordx4 v5, s[32:35], s75 offen lds
    s_mov_b32 m0, 157696
    s_add_u32 s75, s68, 1261760
    buffer_load_dwordx4 v5, s[32:35], s75 offen lds
    s_mov_b32 m0, 72704
    s_add_u32 s75, s68, 401408
    buffer_load_dwordx4 v5, s[32:35], s75 offen lds
    s_mov_b32 m0, 84992
    s_add_u32 s75, s68, 401472
    buffer_load_dwordx4 v5, s[32:35], s75 offen lds
    s_mov_b32 m0, 97280
    s_add_u32 s75, s68, 401536
    buffer_load_dwordx4 v5, s[32:35], s75 offen lds
    s_mov_b32 m0, 109568
    s_add_u32 s75, s68, 401600
    buffer_load_dwordx4 v5, s[32:35], s75 offen lds
    s_mov_b32 m0, 121856
    s_add_u32 s75, s68, 1318912
    buffer_load_dwordx4 v5, s[32:35], s75 offen lds
    s_mov_b32 m0, 134144
    s_add_u32 s75, s68, 1318976
    buffer_load_dwordx4 v5, s[32:35], s75 offen lds
    s_mov_b32 m0, 146432
    s_add_u32 s75, s68, 1319040
    buffer_load_dwordx4 v5, s[32:35], s75 offen lds
    s_mov_b32 m0, 158720
    s_add_u32 s75, s68, 1319104
    buffer_load_dwordx4 v5, s[32:35], s75 offen lds
    s_mov_b32 m0, 73728
    s_add_u32 s75, s68, 458752
    buffer_load_dwordx4 v5, s[32:35], s75 offen lds
    s_mov_b32 m0, 86016
    s_add_u32 s75, s68, 458816
    buffer_load_dwordx4 v5, s[32:35], s75 offen lds
    s_mov_b32 m0, 98304
    s_add_u32 s75, s68, 458880
    buffer_load_dwordx4 v5, s[32:35], s75 offen lds
    s_mov_b32 m0, 110592
    s_add_u32 s75, s68, 458944
    buffer_load_dwordx4 v5, s[32:35], s75 offen lds
    s_mov_b32 m0, 122880
    s_add_u32 s75, s68, 1376256
    buffer_load_dwordx4 v5, s[32:35], s75 offen lds
    s_mov_b32 m0, 135168
    s_add_u32 s75, s68, 1376320
    buffer_load_dwordx4 v5, s[32:35], s75 offen lds
    s_mov_b32 m0, 147456
    s_add_u32 s75, s68, 1376384
    buffer_load_dwordx4 v5, s[32:35], s75 offen lds
    s_mov_b32 m0, 159744
    s_add_u32 s75, s68, 1376448
    buffer_load_dwordx4 v5, s[32:35], s75 offen lds
    s_mov_b32 m0, 74752
    s_add_u32 s75, s68, 516096
    buffer_load_dwordx4 v5, s[32:35], s75 offen lds
    s_mov_b32 m0, 87040
    s_add_u32 s75, s68, 516160
    buffer_load_dwordx4 v5, s[32:35], s75 offen lds
    s_mov_b32 m0, 99328
    s_add_u32 s75, s68, 516224
    buffer_load_dwordx4 v5, s[32:35], s75 offen lds
    s_mov_b32 m0, 111616
    s_add_u32 s75, s68, 516288
    buffer_load_dwordx4 v5, s[32:35], s75 offen lds
    s_mov_b32 m0, 123904
    s_add_u32 s75, s68, 1433600
    buffer_load_dwordx4 v5, s[32:35], s75 offen lds
    s_mov_b32 m0, 136192
    s_add_u32 s75, s68, 1433664
    buffer_load_dwordx4 v5, s[32:35], s75 offen lds
    s_mov_b32 m0, 148480
    s_add_u32 s75, s68, 1433728
    buffer_load_dwordx4 v5, s[32:35], s75 offen lds
    s_mov_b32 m0, 160768
    s_add_u32 s75, s68, 1433792
    buffer_load_dwordx4 v5, s[32:35], s75 offen lds
    s_mov_b32 m0, 75776
    s_add_u32 s75, s68, 573440
    buffer_load_dwordx4 v5, s[32:35], s75 offen lds
    s_mov_b32 m0, 88064
    s_add_u32 s75, s68, 573504
    buffer_load_dwordx4 v5, s[32:35], s75 offen lds
    s_mov_b32 m0, 100352
    s_add_u32 s75, s68, 573568
    buffer_load_dwordx4 v5, s[32:35], s75 offen lds
    s_mov_b32 m0, 112640
    s_add_u32 s75, s68, 573632
    buffer_load_dwordx4 v5, s[32:35], s75 offen lds
    s_mov_b32 m0, 124928
    s_add_u32 s75, s68, 1490944
    buffer_load_dwordx4 v5, s[32:35], s75 offen lds
    s_mov_b32 m0, 137216
    s_add_u32 s75, s68, 1491008
    buffer_load_dwordx4 v5, s[32:35], s75 offen lds
    s_mov_b32 m0, 149504
    s_add_u32 s75, s68, 1491072
    buffer_load_dwordx4 v5, s[32:35], s75 offen lds
    s_mov_b32 m0, 161792
    s_add_u32 s75, s68, 1491136
    buffer_load_dwordx4 v5, s[32:35], s75 offen lds
    s_mov_b32 m0, 76800
    s_add_u32 s75, s68, 630784
    buffer_load_dwordx4 v5, s[32:35], s75 offen lds
    s_mov_b32 m0, 89088
    s_add_u32 s75, s68, 630848
    buffer_load_dwordx4 v5, s[32:35], s75 offen lds
    s_mov_b32 m0, 101376
    s_add_u32 s75, s68, 630912
    buffer_load_dwordx4 v5, s[32:35], s75 offen lds
    s_mov_b32 m0, 113664
    s_add_u32 s75, s68, 630976
    buffer_load_dwordx4 v5, s[32:35], s75 offen lds
    s_mov_b32 m0, 125952
    s_add_u32 s75, s68, 1548288
    buffer_load_dwordx4 v5, s[32:35], s75 offen lds
    s_mov_b32 m0, 138240
    s_add_u32 s75, s68, 1548352
    buffer_load_dwordx4 v5, s[32:35], s75 offen lds
    s_mov_b32 m0, 150528
    s_add_u32 s75, s68, 1548416
    buffer_load_dwordx4 v5, s[32:35], s75 offen lds
    s_mov_b32 m0, 162816
    s_add_u32 s75, s68, 1548480
    buffer_load_dwordx4 v5, s[32:35], s75 offen lds
    v_lshrrev_b32 v16, 1, v0
    v_and_b32 v17, 1, v0
    s_movk_i32 s72, 3584
    v_mul_u32_u24 v16, s72, v16
    v_lshl_add_u32 v20, v17, 7, v16
    s_add_u32 s75, s68, 688128
    buffer_load_dword v21, v20, s[32:35], s75 offen
    s_add_u32 s75, s68, 802816
    buffer_load_dword v21, v20, s[32:35], s75 offen
    s_add_u32 s75, s68, 1605632
    buffer_load_dword v21, v20, s[32:35], s75 offen
    s_add_u32 s75, s68, 1720320
    buffer_load_dword v21, v20, s[32:35], s75 offen
    s_waitcnt vmcnt(4)
L_LJOIN:
    s_barrier
    s_cmp_lg_u32 s100, 0
    s_cbranch_scc1 L_TRG1
    s_mov_b64 exec, 1
    v_mov_b32 v12, s65
    s_cmp_eq_u32 s63, 0
    s_cbranch_scc1 L_SLOW13
    buffer_store_dword v12, off, s[56:59], 0 offset:640
    s_branch L_DONE13
L_SLOW13:
    buffer_store_dword v12, off, s[56:59], 0 offset:640 sc1
L_DONE13:
    s_mov_b64 exec, -1
L_TRG1:
    s_cmp_ge_u32 s100, 14
    s_cbranch_scc0 L_TRG2
    s_mov_b32 s3, 200000
L_POLLT:
    s_cmp_eq_u32 s63, 0
    s_cbranch_scc1 L_SLOW14
    buffer_load_dword v14, off, s[56:59], 0 offset:640 nt
    s_branch L_DONE14
L_SLOW14:
    buffer_load_dword v14, off, s[56:59], 0 offset:640 sc1
L_DONE14:
    s_waitcnt vmcnt(0)
    v_cmp_ne_u32 vcc, s65, v14
    s_sub_u32 s3, s3, 1
    s_cbranch_scc1 L_POLLTX
    s_cmp_lg_u64 vcc, 0
    s_cbranch_scc1 L_POLLT
L_POLLTX:
    s_lshr_b32 s72, s101, 2
    s_lshl_b32 s72, s72, 1
    s_add_u32 s72, s72, s100
    s_sub_u32 s72, s72, 14
    v_lshlrev_b32 v20, 7, v0
    s_mul_i32 s72, s72, 458752
    s_add_u32 s73, s72, 131072
    buffer_load_dword v21, v20, s[36:39], s73 offen
    s_add_u32 s73, s72, 139264
    buffer_load_dword v21, v20, s[36:39], s73 offen
    s_add_u32 s73, s72, 360448
    buffer_load_dword v21, v20, s[36:39], s73 offen
    s_add_u32 s73, s72, 368640
    buffer_load_dword v21, v20, s[36:39], s73 offen
    s_add_u32 s73, s72, 147456
    buffer_load_dword v21, v20, s[36:39], s73 offen
    s_add_u32 s73, s72, 155648
    buffer_load_dword v21, v20, s[36:39], s73 offen
    s_add_u32 s73, s72, 376832
    buffer_load_dword v21, v20, s[36:39], s73 offen
    s_add_u32 s73, s72, 385024
    buffer_load_dword v21, v20, s[36:39], s73 offen
    s_add_u32 s73, s72, 163840
    buffer_load_dword v21, v20, s[36:39], s73 offen
    s_add_u32 s73, s72, 172032
    buffer_load_dword v21, v20, s[36:39], s73 offen
    s_add_u32 s73, s72, 393216
    buffer_load_dword v21, v20, s[36:39], s73 offen
    s_add_u32 s73, s72, 401408
    buffer_load_dword v21, v20, s[36:39], s73 offen
    s_add_u32 s73, s72, 180224
    buffer_load_dword v21, v20, s[36:39], s73 offen
    s_add_u32 s73, s72, 188416
    buffer_load_dword v21, v20, s[36:39], s73 offen
    s_add_u32 s73, s72, 409600
    buffer_load_dword v21, v20, s[36:39], s73 offen
    s_add_u32 s73, s72, 417792
    buffer_load_dword v21, v20, s[36:39], s73 offen
    s_add_u32 s73, s72, 196608
    buffer_load_dword v21, v20, s[36:39], s73 offen
    s_add_u32 s73, s72, 204800
    buffer_load_dword v21, v20, s[36:39], s73 offen
    s_add_u32 s73, s72, 425984
    buffer_load_dword v21, v20, s[36:39], s73 offen
    s_add_u32 s73, s72, 434176
    buffer_load_dword v21, v20, s[36:39], s73 offen
    s_add_u32 s73, s72, 212992
    buffer_load_dword v21, v20, s[36:39], s73 offen
    s_add_u32 s73, s72, 221184
    buffer_load_dword v21, v20, s[36:39], s73 offen
    s_add_u32 s73, s72, 442368
    buffer_load_dword v21, v20, s[36:39], s73 offen
    s_add_u32 s73, s72, 450560
    buffer_load_dword v21, v20, s[36:39], s73 offen
L_TRG2:
    s_barrier
    s_barrier
    s_cmp_ge_u32 s100, 14
    s_cbranch_scc1 L_LNOF2
    s_mov_b64 exec, 1
    s_lshl_b32 s72, s100, 2
    v_mov_b32 v12, s65
    s_cmp_eq_u32 s63, 0
    s_cbranch_scc1 L_SLOW15
    buffer_store_dword v12, off, s[56:59], s72 offset:256
    s_branch L_DONE15
L_SLOW15:
    buffer_store_dword v12, off, s[56:59], s72 offset:256 sc1
L_DONE15:
    s_mov_b64 exec, -1
L_LNOF2:
    s_mov_b32 s3, 200000
L_POLL2:
    s_cmp_eq_u32 s63, 0
    s_cbranch_scc1 L_SLOW16
    buffer_load_dword v14, v11, s[56:59], 0 offen offset:256 nt
    s_branch L_DONE16
L_SLOW16:
    buffer_load_dword v14, v11, s[56:59], 0 offen offset:256 sc1
L_DONE16:
    s_waitcnt vmcnt(0)
    v_cmp_ne_u32 vcc, s65, v14
    s_sub_u32 s3, s3, 1
    s_cbranch_scc1 L_POLLX2
    s_cmp_lg_u64 vcc, 0
    s_cbranch_scc1 L_POLL2
L_POLLX2:
    s_cmp_lg_u32 s100, 0
    s_cbranch_scc1 L_NOEPOCH
    s_mov_b64 exec, 1
    v_mov_b32 v12, s65
    buffer_store_dword v12, off, s[56:59], 0 offset:384 sc1
    s_mov_b64 exec, -1
L_NOEPOCH:
    s_barrier
    s_barrier
    s_endpgm
L_END:
    s_endpgm
.section .rodata,"a"
.p2align 6
.amdhsa_kernel standalone__mixer_s_mlp__sampling_kernel
  .amdhsa_next_free_vgpr 152
  .amdhsa_next_free_sgpr 102
  .amdhsa_accum_offset 152
  .amdhsa_group_segment_fixed_size 0
  .amdhsa_kernarg_size 64
  .amdhsa_user_sgpr_count 2
  .amdhsa_user_sgpr_kernarg_segment_ptr 1
  .amdhsa_system_sgpr_workgroup_id_x 1
  .amdhsa_float_denorm_mode_32 3
.end_amdhsa_kernel
```
